```python
import torch

def _softmax(x, axis=-1):
    return torch.softmax(x, dim=axis)

def _gelu(x):
    return torch.nn.functional.gelu(x, approximate='tanh')

def _silu(x):
    return torch.nn.functional.silu(x)

def _sigmoid(x):
    return torch.sigmoid(x)

def _layernorm(x, axis=-1, eps=1e-05):
    m = x.mean(dim=axis, keepdim=True)
    v = x.var(dim=axis, keepdim=True, unbiased=False)
    return (x - m) / torch.sqrt(v + eps)

def _scatter_add(tgt, idx, src, axis=0):
    return tgt.clone().index_add_(axis, idx, src)

def _segment_sum(src, seg, n):
    out = torch.zeros((n,) + src.shape[1:], dtype=src.dtype)
    return out.index_add_(0, seg, src)

def _pad(x, pw):
    flat = tuple((v for pair in reversed(pw) for v in pair))
    return torch.nn.functional.pad(x, flat)
kernel_name = 'adaLN_cond__mha_block_cached__glu_gated_geglu__decode'

def setup_inputs():

    _w = lambda a: (lambda t: t.to(torch.bfloat16) if t.is_floating_point() else t)(torch.as_tensor(a))

    def _A_setup():
        B, Sq, D = (1, 1, 512)
        H, Sk, Dh = (32, 65536, 128)
        return {'x': _w((lambda *s: torch.randn(*s, dtype=torch.bfloat16) * 0.05)(B, Sq, D)), 'k_cache': _w((lambda *s: torch.randn(*s, dtype=torch.bfloat16) * 0.8)(B, H, Sk, Dh)), 'v_cache': _w((lambda *s: torch.randn(*s, dtype=torch.bfloat16) * 3.2)(B, H, Sk, Dh)), 'wq': _w((lambda *s: torch.randn(*s, dtype=torch.bfloat16) * 0.8)(D, H * Dh) * D ** (-0.5)), 'wo': _w((lambda *s: torch.randn(*s, dtype=torch.bfloat16) * 3.2)(H * Dh, D) * (H * Dh) ** (-0.5))}
    _A_in = _A_setup()

    def _B_setup():
        B, S, Dm, Df = (1, 1, 512, 1792)
        return {'x': _w((lambda *s: torch.randn(*s, dtype=torch.bfloat16) * 0.05)(B, S, Dm)), 'w_gate': _w((lambda *s: torch.randn(*s, dtype=torch.bfloat16) * 3.2)(Dm, Df) * Dm ** (-0.5)), 'w_up': _w((lambda *s: torch.randn(*s, dtype=torch.bfloat16) * 3.2)(Dm, Df) * Dm ** (-0.5)), 'w_down': _w((lambda *s: torch.randn(*s, dtype=torch.bfloat16) * 3.2)(Df, Dm) * Df ** (-0.5))}
    _B_in = _B_setup()
    return {'A_x': _A_in['x'], 'A_k_cache': _A_in['k_cache'], 'A_v_cache': _A_in['v_cache'], 'A_wq': _A_in['wq'], 'A_wo': _A_in['wo'], 'B_x': _B_in['x'], 'B_w_gate': _B_in['w_gate'], 'B_w_up': _B_in['w_up'], 'B_w_down': _B_in['w_down'], 'c': _w((lambda *s: torch.randn(*s, dtype=torch.bfloat16) * 0.4)(1, 512) * 8.0), 'w_mod': _w((lambda *s: torch.randn(*s, dtype=torch.bfloat16) * 0.4)(512, 6 * 512) * 512 ** (-0.5) * 8.0)}

def reference(A_x, A_k_cache, A_v_cache, A_wq, A_wo, B_x, B_w_gate, B_w_up, B_w_down, c, w_mod):

    def _A_ref(x, k_cache, v_cache, wq, wo):
        B, Sq, D = x.shape
        H, Dh = (32, 128)
        q = (lambda x, *d: x.permute(*d))((x @ wq).reshape(B, Sq, H, Dh), 0, 2, 1, 3)
        scores = torch.einsum('bhqd,bhkd->bhqk', q, k_cache) * Dh ** (-0.5)
        p = _softmax(scores, axis=-1)
        o = torch.einsum('bhqk,bhkd->bhqd', p, v_cache)
        return (lambda x, *d: x.permute(*d))(o, 0, 2, 1, 3).reshape(B, Sq, H * Dh) @ wo

    def _B_ref(x, w_gate, w_up, w_down):
        g = torch.einsum('bsd,df->bsf', x, w_gate)
        u = torch.einsum('bsd,df->bsf', x, w_up)
        h = _gelu(g) * u
        return torch.einsum('bsf,fd->bsd', h, w_down)
    x = A_x
    mod = (_silu(c) @ w_mod).reshape(c.shape[0], 6, 1, -1)
    sa, ca, ga, sb, cb, gb = (mod[:, 0].clone(), mod[:, 1].clone(), mod[:, 2].clone(), mod[:, 3].clone(), mod[:, 4].clone(), mod[:, 5].clone())
    h = _layernorm(x, axis=-1) * (1 + ca) + sa
    x = x + ga * _A_ref(h, A_k_cache, A_v_cache, A_wq, A_wo)
    h = _layernorm(x, axis=-1) * (1 + cb) + sb
    x = x + gb * _B_ref(h, B_w_gate, B_w_up, B_w_down)
    return x
```

```asm
; @launch grid=(256,1,1) block=(512,1,1) lds=145920
.amdgcn_target "amdgcn-amd-amdhsa--gfx950"
.text
.globl adaLN_cond__mha_block_cached__glu_gated_geglu__decode_kernel
.p2align 8
.type adaLN_cond__mha_block_cached__glu_gated_geglu__decode_kernel,@function
adaLN_cond__mha_block_cached__glu_gated_geglu__decode_kernel:
    s_cmp_ge_u32 s2, 256
    s_cbranch_scc1 L_end
    s_load_dwordx16 s[68:83], s[0:1], 0
    s_load_dwordx8 s[84:91], s[0:1], 64
    s_load_dwordx4 s[92:95], s[0:1], 96
    s_memrealtime s[100:101]
    v_lshrrev_b32 v1, 6, v0
    v_and_b32 v0, 63, v0
    s_lshr_b32 s4, s2, 3
    v_readfirstlane_b32 s3, v1
    s_and_b32 s5, s2, 7
    v_lshlrev_b32 v4, 4, v0
    v_add_u32 v5, 4096, v4
    v_add_u32 v6, 32768, v4
    v_add_u32 v7, 36864, v4
    s_getreg_b32 s58, hwreg(HW_REG_XCC_ID)
    s_and_b32 s58, s58, 7
    s_mov_b32 s10, 0
    s_mov_b32 s42, 0xaaaaaaaa
    s_mov_b32 s43, 0xaaaaaaaa
    s_mov_b32 s44, 0xcccccccc
    s_mov_b32 s45, 0xcccccccc
    s_mov_b32 s46, 0x3fb8aa3b
    s_mov_b32 s47, 0x3db504f3
    s_mov_b32 s48, 0x05040100
    s_mov_b32 s49, 0x07060302
    s_mov_b32 s15, 0
    v_mov_b32 v12, 0xff7fffff
    v_mov_b32 v13, 0
    v_mov_b32 v14, 0
    v_lshlrev_b32 v15, 1, v0
    s_lshr_b32 s6, s4, 2
    s_sub_u32 s59, s5, s6
    s_and_b32 s59, s59, 7
    s_lshl_b32 s96, s5, 7
    s_add_u32 s6, s96, s3
    s_lshr_b32 s7, s6, 2
    s_lshl_b32 s7, s7, 16
    s_and_b32 s54, s6, 3
    s_lshl_b32 s54, s54, 13
    s_or_b32 s54, s54, s7
    s_add_u32 s55, s54, 131072
    s_add_u32 s56, s54, 262144
    v_lshlrev_b32 v240, 2, v0
    v_mov_b32 v241, 1
    s_mov_b32 s53, 1
    s_lshl_b32 s6, s3, 11
    s_add_u32 s6, s6, 1024
    v_lshlrev_b32 v244, 2, v0
    v_add_u32 v244, s6, v244
    s_lshl_b32 s7, s4, 24
    s_lshl_b32 s8, s4, 8
    s_lshl_b32 s9, s4, 17
    s_add_u32 s9, s9, 0x400000
    s_lshl_b32 s63, 1, s59
    s_mov_b32 s18, 0x1000000
    s_mov_b32 s19, 0x20000
    s_waitcnt lgkmcnt(0)
    s_add_u32 s16, s70, s7
    s_addc_u32 s17, s71, 0
    s_and_b32 s63, s63, 0x96
    s_cbranch_scc0 L_noearly
    buffer_load_dwordx4 v[112:115], v4, s[16:19], s54 offen offset:0 nt
    buffer_load_dwordx4 v[116:119], v6, s[16:19], s54 offen offset:0 nt
    buffer_load_dwordx4 v[120:123], v4, s[16:19], s54 offen offset:1024 nt
    buffer_load_dwordx4 v[124:127], v6, s[16:19], s54 offen offset:1024 nt
    buffer_load_dwordx4 v[128:131], v4, s[16:19], s54 offen offset:2048 nt
    buffer_load_dwordx4 v[132:135], v6, s[16:19], s54 offen offset:2048 nt
L_noearly:
    s_lshl_b32 s6, s3, 8
    s_or_b32 s6, s6, s2
    s_sub_u32 s6, s6, 0x701
    s_cmp_ge_u32 s6, 7
    s_cbranch_scc1 L_noepoch_1
    s_or_b32 s100, s100, 1
    s_mov_b32 s101, 0
    s_atomic_cmpswap s[100:101], s[92:93], 0x0 glc
    s_waitcnt lgkmcnt(0)
L_noepoch_1:
    s_add_u32 s20, s72, s7
    s_addc_u32 s21, s73, 0
    s_mov_b32 s22, 0x1000000
    s_mov_b32 s23, 0x20000
    s_mov_b32 s28, s94
    s_mov_b32 s29, s95
    s_mov_b32 s30, 0x800000
    s_mov_b32 s31, 0x20000
    s_add_u32 s36, s94, s9
    s_addc_u32 s37, s95, 0
    s_mov_b32 s38, 0x20000
    s_mov_b32 s39, 0x20000
    s_add_u32 s40, s94, s8
    s_addc_u32 s41, s95, 0
    s_lshl_b32 s6, s59, 2
    s_lshr_b32 s6, 0x3ff2f10f, s6
    s_and_b32 s6, s6, 15
    s_lshl_b32 s6, s6, 2
    s_and_b32 s7, s4, 3
    s_add_u32 s6, s6, s7
    s_mul_i32 s60, s5, 14
    s_add_u32 s60, s60, s6
    s_cmp_lt_u32 s6, 14
    s_cselect_b32 s60, s60, -1
    s_lshl_b32 s61, s5, 2
    s_add_u32 s61, s61, s7
    s_cmp_eq_u32 s59, 3
    s_cselect_b32 s61, s61, -1
    s_lshr_b32 s62, s3, 2
    s_cmp_lg_u32 s61, -1
    s_cselect_b32 s97, 56, 0
    s_cmp_eq_u32 s59, 0
    s_cselect_b32 s97, 48, s97
    s_cmp_eq_u32 s59, 6
    s_cselect_b32 s97, 56, s97
    v_mov_b32 v1, 320
    v_mov_b32 v2, 0
    v_mov_b32 v3, 0
    s_cmp_lg_u32 s3, 0
    s_cbranch_scc1 L_li_2
    ds_write_b64 v1, v[2:3]
    ds_write_b64 v1, v[2:3] offset:24
    ds_write_b64 v1, v[2:3] offset:32
    v_add_u32 v3, 144384, v240
    ds_write_b32 v3, v2
    v_add_u32 v3, 144896, v4
    v_mov_b32 v16, -1
    v_mov_b32 v17, -1
    v_mov_b32 v18, -1
    v_mov_b32 v19, -1
    ds_write_b128 v3, v[16:19]
    v_mov_b32 v3, 0
    s_cmp_eq_u32 s59, 6
    s_cselect_b32 s6, 8, 24
    v_mov_b32 v2, s6
    ds_write_b64 v1, v[2:3] offset:8
    s_waitcnt lgkmcnt(0)
L_li_2:
    s_cmp_eq_u32 s59, 0
    s_cbranch_scc1 L_mod
    s_cmp_eq_u32 s59, 3
    s_cbranch_scc1 L_mod
    s_cmp_eq_u32 s59, 5
    s_cbranch_scc1 L_mod
    s_cmp_eq_u32 s59, 6
    s_cbranch_scc1 L_qtask
L_plain:
    s_barrier
    s_branch L_prefetch
L_mod:
    s_mov_b32 s24, s88
    s_mov_b32 s25, s89
    s_mov_b32 s26, 0x300000
    s_mov_b32 s27, 0x20000
    v_lshrrev_b32 v1, 1, v0
    s_lshl_b32 s6, s3, 5
    v_add_u32 v1, s6, v1
    s_mov_b32 s7, 12288
    v_mul_lo_u32 v73, s7, v1
    v_and_b32 v2, 1, v0
    v_lshlrev_b32 v2, 4, v2
    v_add_u32 v73, v73, v2
    v_lshlrev_b32 v1, 2, v1
    s_mov_b32 s6, 0
    s_mov_b32 s7, 1024
    s_cmp_eq_u32 s59, 3
    s_cselect_b32 s6, 3072, s6
    s_cselect_b32 s7, 4096, s7
    s_cmp_eq_u32 s59, 5
    s_cselect_b32 s6, 2048, s6
    s_cselect_b32 s7, 5120, s7
    s_lshl_b32 s8, s4, 5
    s_add_u32 s6, s6, s8
    s_add_u32 s7, s7, s8
    s_add_u32 s8, s6, 6144
    s_add_u32 s9, s7, 6144
    global_load_dword v64, v1, s[86:87]
    buffer_load_dwordx4 v[48:51], v73, s[24:27], s6 offen nt
    buffer_load_dwordx4 v[52:55], v73, s[24:27], s8 offen nt
    buffer_load_dwordx4 v[56:59], v73, s[24:27], s7 offen nt
    buffer_load_dwordx4 v[60:63], v73, s[24:27], s9 offen nt
    s_cmp_eq_u32 s59, 0
    s_cbranch_scc1 L_mod0
    buffer_load_dwordx4 v[112:115], v4, s[16:19], s54 offen offset:0 nt
    buffer_load_dwordx4 v[116:119], v6, s[16:19], s54 offen offset:0 nt
    buffer_load_dwordx4 v[120:123], v4, s[16:19], s54 offen offset:1024 nt
    buffer_load_dwordx4 v[124:127], v6, s[16:19], s54 offen offset:1024 nt
    buffer_load_dwordx4 v[128:131], v4, s[16:19], s54 offen offset:2048 nt
    buffer_load_dwordx4 v[132:135], v6, s[16:19], s54 offen offset:2048 nt
    s_waitcnt vmcnt(6)
    s_branch L_modc
L_mod0:
    s_setprio 2
    s_cmp_eq_u32 s3, 0
    s_cbranch_scc1 L_mod00
    s_waitcnt vmcnt(0)
    s_branch L_modc
L_mod00:
    global_load_dwordx4 v[68:71], v4, s[68:69]
    v_and_b32 v2, 15, v0
    v_lshlrev_b32 v2, 1, v2
    s_lshl_b32 s6, s4, 5
    v_add_u32 v2, s6, v2
    global_load_ushort v72, v2, s[68:69]
    v_mov_b32 v2, 0
    global_store_dword v240, v2, s[40:41] sc1
    s_waitcnt vmcnt(3)
L_modc:
    v_lshlrev_b32 v40, 16, v64
    v_and_b32 v41, 0xffff0000, v64
    v_mul_f32 v42, s46, v40
    v_mul_f32 v43, s46, v41
    s_mov_b32 s6, 0xc2fc0000
    v_max_f32 v42, s6, v42
    v_max_f32 v43, s6, v43
    v_exp_f32 v42, -v42
    v_exp_f32 v43, -v43
    s_nop 0
    v_add_f32 v42, 1.0, v42
    v_add_f32 v43, 1.0, v43
    v_rcp_f32 v44, v42
    v_rcp_f32 v45, v43
    s_nop 0
    v_fma_f32 v46, -v42, v44, 1.0
    v_fma_f32 v47, -v43, v45, 1.0
    v_fma_f32 v44, v46, v44, v44
    v_fma_f32 v45, v47, v45, v45
    v_mul_f32 v46, v40, v44
    v_mul_f32 v47, v41, v45
    v_fma_f32 v1, -v42, v46, v40
    v_fma_f32 v2, -v43, v47, v41
    v_fma_f32 v1, v1, v44, v46
    v_fma_f32 v2, v2, v45, v47
    v_cvt_pk_bf16_f32 v3, v1, v2
    v_perm_b32 v16, v52, v48, s48
    v_perm_b32 v17, v52, v48, s49
    v_perm_b32 v18, v53, v49, s48
    v_perm_b32 v19, v53, v49, s49
    v_perm_b32 v20, v54, v50, s48
    v_perm_b32 v21, v54, v50, s49
    v_perm_b32 v22, v55, v51, s48
    v_perm_b32 v23, v55, v51, s49
    v_perm_b32 v24, v60, v56, s48
    v_perm_b32 v25, v60, v56, s49
    v_perm_b32 v26, v61, v57, s48
    v_perm_b32 v27, v61, v57, s49
    v_perm_b32 v28, v62, v58, s48
    v_perm_b32 v29, v62, v58, s49
    v_perm_b32 v30, v63, v59, s48
    v_perm_b32 v31, v63, v59, s49
    v_dot2_f32_bf16 v176, v16, v3, 0
    v_dot2_f32_bf16 v177, v17, v3, 0
    v_dot2_f32_bf16 v178, v18, v3, 0
    v_dot2_f32_bf16 v179, v19, v3, 0
    v_dot2_f32_bf16 v180, v20, v3, 0
    v_dot2_f32_bf16 v181, v21, v3, 0
    v_dot2_f32_bf16 v182, v22, v3, 0
    v_dot2_f32_bf16 v183, v23, v3, 0
    v_dot2_f32_bf16 v184, v24, v3, 0
    v_dot2_f32_bf16 v185, v25, v3, 0
    v_dot2_f32_bf16 v186, v26, v3, 0
    v_dot2_f32_bf16 v187, v27, v3, 0
    v_dot2_f32_bf16 v188, v28, v3, 0
    v_dot2_f32_bf16 v189, v29, v3, 0
    v_dot2_f32_bf16 v190, v30, v3, 0
    v_dot2_f32_bf16 v191, v31, v3, 0
    s_nop 2
    v_add_f32_dpp v176, v176, v176 row_ror:8 row_mask:0xf bank_mask:0x3
    v_add_f32_dpp v176, v184, v184 row_ror:8 row_mask:0xf bank_mask:0xc
    v_add_f32_dpp v177, v177, v177 row_ror:8 row_mask:0xf bank_mask:0x3
    v_add_f32_dpp v177, v185, v185 row_ror:8 row_mask:0xf bank_mask:0xc
    v_add_f32_dpp v178, v178, v178 row_ror:8 row_mask:0xf bank_mask:0x3
    v_add_f32_dpp v178, v186, v186 row_ror:8 row_mask:0xf bank_mask:0xc
    v_add_f32_dpp v179, v179, v179 row_ror:8 row_mask:0xf bank_mask:0x3
    v_add_f32_dpp v179, v187, v187 row_ror:8 row_mask:0xf bank_mask:0xc
    v_add_f32_dpp v180, v180, v180 row_ror:8 row_mask:0xf bank_mask:0x3
    v_add_f32_dpp v180, v188, v188 row_ror:8 row_mask:0xf bank_mask:0xc
    v_add_f32_dpp v181, v181, v181 row_ror:8 row_mask:0xf bank_mask:0x3
    v_add_f32_dpp v181, v189, v189 row_ror:8 row_mask:0xf bank_mask:0xc
    v_add_f32_dpp v182, v182, v182 row_ror:8 row_mask:0xf bank_mask:0x3
    v_add_f32_dpp v182, v190, v190 row_ror:8 row_mask:0xf bank_mask:0xc
    v_add_f32_dpp v183, v183, v183 row_ror:8 row_mask:0xf bank_mask:0x3
    v_add_f32_dpp v183, v191, v191 row_ror:8 row_mask:0xf bank_mask:0xc
    v_add_f32_dpp v176, v176, v176 row_shl:4 row_mask:0xf bank_mask:0x5
    v_add_f32_dpp v177, v177, v177 row_shl:4 row_mask:0xf bank_mask:0x5
    v_add_f32_dpp v178, v178, v178 row_shl:4 row_mask:0xf bank_mask:0x5
    v_add_f32_dpp v179, v179, v179 row_shl:4 row_mask:0xf bank_mask:0x5
    v_add_f32_dpp v176, v180, v180 row_shr:4 row_mask:0xf bank_mask:0xa
    v_add_f32_dpp v177, v181, v181 row_shr:4 row_mask:0xf bank_mask:0xa
    v_add_f32_dpp v178, v182, v182 row_shr:4 row_mask:0xf bank_mask:0xa
    v_add_f32_dpp v179, v183, v183 row_shr:4 row_mask:0xf bank_mask:0xa
    v_add_f32_dpp v184, v176, v176 quad_perm:[2,3,0,1] row_mask:0xf bank_mask:0xf
    v_add_f32_dpp v185, v178, v178 quad_perm:[2,3,0,1] row_mask:0xf bank_mask:0xf
    v_add_f32_dpp v186, v177, v177 quad_perm:[2,3,0,1] row_mask:0xf bank_mask:0xf
    v_add_f32_dpp v187, v179, v179 quad_perm:[2,3,0,1] row_mask:0xf bank_mask:0xf
    v_cndmask_b32 v176, v184, v185, s[44:45]
    v_cndmask_b32 v177, v186, v187, s[44:45]
    s_nop 1
    v_permlane16_swap_b32 v176, v177
    s_nop 0
    v_add_f32 v176, v176, v177
    v_bfe_u32 v1, v0, 3, 1
    v_lshlrev_b32 v1, 4, v1
    v_and_b32 v2, 1, v0
    v_lshl_add_u32 v1, v2, 3, v1
    v_and_b32 v2, 6, v0
    v_add_u32 v1, v1, v2
    v_bfe_u32 v2, v0, 4, 1
    v_add_u32 v1, v1, v2
    v_bfe_u32 v2, v0, 5, 1
    v_lshl_add_u32 v1, v2, 5, v1
    v_lshlrev_b32 v1, 2, v1
    s_lshl_b32 s6, s3, 8
    v_add_u32 v1, s6, v1
    ds_write_b32 v1, v176 offset:1024
    s_cmp_lg_u32 s3, 0
    s_cbranch_scc1 L_modbar
    s_load_dword s11, s[92:93], 0x0
    s_mov_b32 s52, 0
L_ep_3:
    s_waitcnt lgkmcnt(0)
    s_cmp_lg_u32 s11, 0
    s_cbranch_scc1 L_epd_4
    s_add_u32 s52, s52, 1
    s_cmp_gt_u32 s52, 0x80000
    s_cbranch_scc1 L_end
    s_sleep 4
    s_load_dword s11, s[92:93], 0x0 glc
    s_branch L_ep_3
L_epd_4:
    s_cmp_lg_u32 s59, 0
    s_cbranch_scc1 L_modbar
    s_waitcnt vmcnt(0)
    v_lshlrev_b32 v16, 16, v68
    v_and_b32 v17, 0xffff0000, v68
    v_lshlrev_b32 v18, 16, v69
    v_and_b32 v19, 0xffff0000, v69
    v_lshlrev_b32 v20, 16, v70
    v_and_b32 v21, 0xffff0000, v70
    v_lshlrev_b32 v22, 16, v71
    v_and_b32 v23, 0xffff0000, v71
    v_add_f32 v40, v16, v17
    v_add_f32 v41, v18, v19
    v_add_f32 v42, v20, v21
    v_add_f32 v43, v22, v23
    v_add_f32 v40, v40, v41
    v_add_f32 v42, v42, v43
    v_add_f32 v40, v40, v42
    s_nop 2
    v_add_f32_dpp v40, v40, v40 quad_perm:[1,0,3,2] row_mask:0xf bank_mask:0xf
    s_nop 1
    v_add_f32_dpp v40, v40, v40 quad_perm:[2,3,0,1] row_mask:0xf bank_mask:0xf
    s_nop 1
    v_add_f32_dpp v40, v40, v40 row_ror:4 row_mask:0xf bank_mask:0xf
    s_nop 1
    v_add_f32_dpp v40, v40, v40 row_ror:8 row_mask:0xf bank_mask:0xf
    s_nop 1
    v_mov_b32 v41, v40
    s_nop 1
    v_permlane16_swap_b32 v40, v41
    s_nop 0
    v_add_f32 v40, v40, v41
    v_mov_b32 v41, v40
    s_nop 1
    v_permlane32_swap_b32 v40, v41
    s_nop 0
    v_add_f32 v40, v40, v41
    v_mul_f32 v40, 0x3b000000, v40
    v_sub_f32 v42, v16, v40
    v_sub_f32 v43, v17, v40
    v_mul_f32 v41, v42, v42
    v_mul_f32 v44, v43, v43
    v_sub_f32 v42, v18, v40
    v_sub_f32 v43, v19, v40
    v_fma_f32 v41, v42, v42, v41
    v_fma_f32 v44, v43, v43, v44
    v_sub_f32 v42, v20, v40
    v_sub_f32 v43, v21, v40
    v_fma_f32 v41, v42, v42, v41
    v_fma_f32 v44, v43, v43, v44
    v_sub_f32 v42, v22, v40
    v_sub_f32 v43, v23, v40
    v_fma_f32 v41, v42, v42, v41
    v_fma_f32 v44, v43, v43, v44
    v_add_f32 v41, v41, v44
    s_nop 2
    v_add_f32_dpp v41, v41, v41 quad_perm:[1,0,3,2] row_mask:0xf bank_mask:0xf
    s_nop 1
    v_add_f32_dpp v41, v41, v41 quad_perm:[2,3,0,1] row_mask:0xf bank_mask:0xf
    s_nop 1
    v_add_f32_dpp v41, v41, v41 row_ror:4 row_mask:0xf bank_mask:0xf
    s_nop 1
    v_add_f32_dpp v41, v41, v41 row_ror:8 row_mask:0xf bank_mask:0xf
    s_nop 1
    v_mov_b32 v42, v41
    s_nop 1
    v_permlane16_swap_b32 v41, v42
    s_nop 0
    v_add_f32 v41, v41, v42
    v_mov_b32 v42, v41
    s_nop 1
    v_permlane32_swap_b32 v41, v42
    s_nop 0
    v_add_f32 v41, v41, v42
    v_mul_f32 v41, 0x3b000000, v41
    v_mov_b32 v74, v40
    v_cvt_pk_bf16_f32 v41, v41, v41
    v_cvt_pk_bf16_f32 v74, v74, v74
    v_lshlrev_b32 v41, 16, v41
    v_lshlrev_b32 v74, 16, v74
    v_add_f32 v41, 0x3727c5ac, v41
    v_cvt_pk_bf16_f32 v41, v41, v41
    v_lshlrev_b32 v41, 16, v41
    v_sqrt_f32 v42, v41
    s_nop 0
    v_rcp_f32 v43, v42
    v_fma_f32 v44, -v42, v42, v41
    v_mul_f32 v43, 0.5, v43
    v_fma_f32 v75, v44, v43, v42
    v_cvt_pk_bf16_f32 v75, v75, v75
    v_lshlrev_b32 v75, 16, v75
    v_rcp_f32 v76, v75
    s_nop 0
    v_fma_f32 v42, -v75, v76, 1.0
    v_fma_f32 v76, v42, v76, v76
    v_lshlrev_b32 v72, 16, v72
L_modbar:
    s_waitcnt lgkmcnt(0)
    s_barrier
    s_cmp_lg_u32 s3, 0
    s_cbranch_scc1 L_moddone
    v_and_b32 v1, 15, v0
    v_lshlrev_b32 v1, 2, v1
    v_lshrrev_b32 v2, 4, v0
    v_lshl_add_u32 v1, v2, 9, v1
    v_add_u32 v1, 1024, v1
    ds_read2_b32 v[16:17], v1 offset0:0 offset1:16
    ds_read2_b32 v[18:19], v1 offset0:32 offset1:48
    ds_read2_b32 v[20:21], v1 offset0:64 offset1:80
    ds_read2_b32 v[22:23], v1 offset0:96 offset1:112
    s_waitcnt lgkmcnt(0)
    v_add_f32 v16, v16, v18
    v_add_f32 v17, v17, v19
    v_add_f32 v20, v20, v22
    v_add_f32 v21, v21, v23
    v_add_f32 v16, v16, v20
    v_add_f32 v17, v17, v21
    v_mov_b32 v18, v16
    v_mov_b32 v19, v17
    s_nop 1
    v_permlane16_swap_b32 v16, v18
    v_permlane16_swap_b32 v17, v19
    s_nop 0
    v_add_f32 v16, v16, v18
    v_add_f32 v17, v17, v19
    v_mov_b32 v18, v16
    v_mov_b32 v19, v17
    s_nop 1
    v_permlane32_swap_b32 v16, v18
    v_permlane32_swap_b32 v17, v19
    s_nop 0
    v_add_f32 v16, v16, v18
    v_add_f32 v17, v17, v19
    v_cvt_pk_bf16_f32 v16, v16, v16
    v_cvt_pk_bf16_f32 v17, v17, v17
    v_lshlrev_b32 v16, 16, v16
    v_lshlrev_b32 v17, 16, v17
    v_mov_b32 v25, s11
    v_mov_b32 v27, s11
    v_bfe_u32 v1, v0, 1, 3
    v_lshrrev_b32 v2, 4, v0
    s_cmp_lg_u32 s59, 0
    s_cbranch_scc1 L_pub12
    v_sub_f32 v21, v72, v74
    v_add_f32 v17, 1.0, v17
    v_cvt_pk_bf16_f32 v21, v21, v21
    v_cvt_pk_bf16_f32 v17, v17, v17
    v_lshlrev_b32 v21, 16, v21
    v_lshlrev_b32 v17, 16, v17
    v_mul_f32 v22, v21, v76
    v_fma_f32 v20, -v75, v22, v21
    v_fma_f32 v20, v20, v76, v22
    v_cvt_pk_bf16_f32 v20, v20, v20
    v_lshlrev_b32 v20, 16, v20
    v_mul_f32 v20, v20, v17
    v_cvt_pk_bf16_f32 v20, v20, v20
    v_lshlrev_b32 v20, 16, v20
    v_add_f32 v20, v20, v16
    v_cvt_pk_bf16_f32 v20, v20, v20
    v_lshlrev_b32 v20, 16, v20
    v_lshlrev_b32 v1, 3, v1
    v_lshl_add_u32 v1, v2, 12, v1
    v_add_u32 v1, 0x2000, v1
    v_mov_b32_dpp v21, v20 quad_perm:[1,0,3,2] row_mask:0xf bank_mask:0xf
    s_lshl_b32 s6, s4, 7
    s_add_u32 s7, s6, 16384
    v_cvt_pk_bf16_f32 v24, v20, v21
    s_not_b64 exec, s[42:43]
    buffer_store_dwordx2 v[24:25], v1, s[28:31], s6 offen sc1
    buffer_store_dwordx2 v[24:25], v1, s[28:31], s7 offen sc1
    s_mov_b64 exec, -1
    s_branch L_moddone
L_pub12:
    v_mov_b32_dpp v20, v16 quad_perm:[1,0,3,2] row_mask:0xf bank_mask:0xf
    v_mov_b32_dpp v21, v17 quad_perm:[1,0,3,2] row_mask:0xf bank_mask:0xf
    v_lshlrev_b32 v1, 4, v1
    v_lshl_add_u32 v1, v2, 12, v1
    v_add_u32 v1, 0x10000, v1
    v_cvt_pk_bf16_f32 v24, v16, v20
    v_cvt_pk_bf16_f32 v26, v17, v21
    s_lshl_b32 s6, s4, 7
    s_cmp_eq_u32 s59, 5
    s_cselect_b32 s7, 0x8000, 0
    s_add_u32 s6, s6, s7
    s_add_u32 s7, s6, 16384
    s_not_b64 exec, s[42:43]
    buffer_store_dwordx4 v[24:27], v1, s[28:31], s6 offen sc1
    buffer_store_dwordx4 v[24:27], v1, s[28:31], s7 offen sc1
    s_mov_b64 exec, -1
L_moddone:
    s_setprio 0
    s_cmp_lg_u32 s59, 0
    s_cbranch_scc1 L_mod12
    buffer_load_dwordx4 v[112:115], v4, s[16:19], s54 offen offset:0 nt
    buffer_load_dwordx4 v[116:119], v6, s[16:19], s54 offen offset:0 nt
    buffer_load_dwordx4 v[120:123], v4, s[16:19], s54 offen offset:1024 nt
    buffer_load_dwordx4 v[124:127], v6, s[16:19], s54 offen offset:1024 nt
    buffer_load_dwordx4 v[128:131], v4, s[16:19], s54 offen offset:2048 nt
    buffer_load_dwordx4 v[132:135], v6, s[16:19], s54 offen offset:2048 nt
L_mod12:
    s_branch L_prefetch
L_qtask:
    v_and_b32 v2, 15, v0
    v_lshlrev_b32 v2, 1, v2
    s_lshl_b32 s6, s4, 5
    v_add_u32 v2, s6, v2
    global_load_ushort v250, v2, s[68:69]
    s_mov_b32 s24, s74
    s_mov_b32 s25, s75
    s_mov_b32 s26, 0x400000
    s_mov_b32 s27, 0x20000
    v_lshrrev_b32 v1, 4, v0
    v_lshlrev_b32 v1, 17, v1
    v_and_b32 v2, 15, v0
    v_lshlrev_b32 v2, 4, v2
    v_add_u32 v1, v1, v2
    s_lshl_b32 s6, s3, 19
    s_lshl_b32 s7, s4, 8
    s_add_u32 s6, s6, s7
    buffer_load_dwordx4 v[112:115], v1, s[24:27], s6 offen nt
    s_add_u32 s6, s6, 8192
    buffer_load_dwordx4 v[116:119], v1, s[24:27], s6 offen nt
    s_add_u32 s6, s6, 8192
    buffer_load_dwordx4 v[120:123], v1, s[24:27], s6 offen nt
    s_add_u32 s6, s6, 8192
    buffer_load_dwordx4 v[124:127], v1, s[24:27], s6 offen nt
    s_add_u32 s6, s6, 8192
    buffer_load_dwordx4 v[128:131], v1, s[24:27], s6 offen nt
    s_add_u32 s6, s6, 8192
    buffer_load_dwordx4 v[132:135], v1, s[24:27], s6 offen nt
    s_add_u32 s6, s6, 8192
    buffer_load_dwordx4 v[136:139], v1, s[24:27], s6 offen nt
    s_add_u32 s6, s6, 8192
    buffer_load_dwordx4 v[140:143], v1, s[24:27], s6 offen nt
    s_add_u32 s6, s6, 8192
    buffer_load_dwordx4 v[144:147], v1, s[24:27], s6 offen nt
    s_add_u32 s6, s6, 8192
    buffer_load_dwordx4 v[148:151], v1, s[24:27], s6 offen nt
    s_add_u32 s6, s6, 8192
    buffer_load_dwordx4 v[152:155], v1, s[24:27], s6 offen nt
    s_add_u32 s6, s6, 8192
    buffer_load_dwordx4 v[156:159], v1, s[24:27], s6 offen nt
    s_add_u32 s6, s6, 8192
    buffer_load_dwordx4 v[160:163], v1, s[24:27], s6 offen nt
    s_add_u32 s6, s6, 8192
    buffer_load_dwordx4 v[164:167], v1, s[24:27], s6 offen nt
    s_add_u32 s6, s6, 8192
    buffer_load_dwordx4 v[168:171], v1, s[24:27], s6 offen nt
    s_add_u32 s6, s6, 8192
    buffer_load_dwordx4 v[172:175], v1, s[24:27], s6 offen nt
    s_mov_b32 s53, 0
    s_mov_b32 s56, s54
    s_waitcnt vmcnt(0)
    v_perm_b32 v176, v116, v112, s48
    v_perm_b32 v177, v116, v112, s49
    v_perm_b32 v178, v117, v113, s48
    v_perm_b32 v179, v117, v113, s49
    v_perm_b32 v180, v118, v114, s48
    v_perm_b32 v181, v118, v114, s49
    v_perm_b32 v182, v119, v115, s48
    v_perm_b32 v183, v119, v115, s49
    v_perm_b32 v184, v124, v120, s48
    v_perm_b32 v185, v124, v120, s49
    v_perm_b32 v186, v125, v121, s48
    v_perm_b32 v187, v125, v121, s49
    v_perm_b32 v188, v126, v122, s48
    v_perm_b32 v189, v126, v122, s49
    v_perm_b32 v190, v127, v123, s48
    v_perm_b32 v191, v127, v123, s49
    v_perm_b32 v192, v132, v128, s48
    v_perm_b32 v193, v132, v128, s49
    v_perm_b32 v194, v133, v129, s48
    v_perm_b32 v195, v133, v129, s49
    v_perm_b32 v196, v134, v130, s48
    v_perm_b32 v197, v134, v130, s49
    v_perm_b32 v198, v135, v131, s48
    v_perm_b32 v199, v135, v131, s49
    v_perm_b32 v200, v140, v136, s48
    v_perm_b32 v201, v140, v136, s49
    v_perm_b32 v202, v141, v137, s48
    v_perm_b32 v203, v141, v137, s49
    v_perm_b32 v204, v142, v138, s48
    v_perm_b32 v205, v142, v138, s49
    v_perm_b32 v206, v143, v139, s48
    v_perm_b32 v207, v143, v139, s49
    v_perm_b32 v208, v148, v144, s48
    v_perm_b32 v209, v148, v144, s49
    v_perm_b32 v210, v149, v145, s48
    v_perm_b32 v211, v149, v145, s49
    v_perm_b32 v212, v150, v146, s48
    v_perm_b32 v213, v150, v146, s49
    v_perm_b32 v214, v151, v147, s48
    v_perm_b32 v215, v151, v147, s49
    v_perm_b32 v216, v156, v152, s48
    v_perm_b32 v217, v156, v152, s49
    v_perm_b32 v218, v157, v153, s48
    v_perm_b32 v219, v157, v153, s49
    v_perm_b32 v220, v158, v154, s48
    v_perm_b32 v221, v158, v154, s49
    v_perm_b32 v222, v159, v155, s48
    v_perm_b32 v223, v159, v155, s49
    v_perm_b32 v224, v164, v160, s48
    v_perm_b32 v225, v164, v160, s49
    v_perm_b32 v226, v165, v161, s48
    v_perm_b32 v227, v165, v161, s49
    v_perm_b32 v228, v166, v162, s48
    v_perm_b32 v229, v166, v162, s49
    v_perm_b32 v230, v167, v163, s48
    v_perm_b32 v231, v167, v163, s49
    v_perm_b32 v232, v172, v168, s48
    v_perm_b32 v233, v172, v168, s49
    v_perm_b32 v234, v173, v169, s48
    v_perm_b32 v235, v173, v169, s49
    v_perm_b32 v236, v174, v170, s48
    v_perm_b32 v237, v174, v170, s49
    v_perm_b32 v238, v175, v171, s48
    v_perm_b32 v239, v175, v171, s49
    s_load_dword s11, s[92:93], 0x0
    s_mov_b32 s52, 0
L_ep_5:
    s_waitcnt lgkmcnt(0)
    s_cmp_lg_u32 s11, 0
    s_cbranch_scc1 L_epd_6
    s_add_u32 s52, s52, 1
    s_cmp_gt_u32 s52, 0x80000
    s_cbranch_scc1 L_end
    s_sleep 4
    s_load_dword s11, s[92:93], 0x0 glc
    s_branch L_ep_5
L_epd_6:
    v_lshrrev_b32 v3, 4, v0
    v_lshlrev_b32 v3, 7, v3
    v_add_u32 v3, 0x2000, v3
    s_lshl_b32 s8, s58, 12
    s_lshl_b32 s6, s3, 9
    s_add_u32 s8, s8, s6
    s_mov_b32 s52, 0
L_poll_7:
    buffer_load_dwordx4 v[112:115], v3, s[28:31], s8 offen offset:0 sc1
    buffer_load_dwordx4 v[116:119], v3, s[28:31], s8 offen offset:16 sc1
    buffer_load_dwordx4 v[120:123], v3, s[28:31], s8 offen offset:32 sc1
    buffer_load_dwordx4 v[124:127], v3, s[28:31], s8 offen offset:48 sc1
    s_add_u32 s52, s52, 1
    s_cmp_gt_u32 s52, 0x80000
    s_cbranch_scc1 L_end
    s_waitcnt vmcnt(0)
    v_xor_b32 v1, s11, v113
    v_xor_b32 v2, s11, v115
    v_or_b32 v1, v1, v2
    v_xor_b32 v2, s11, v117
    v_or_b32 v1, v1, v2
    v_xor_b32 v2, s11, v119
    v_or_b32 v1, v1, v2
    v_xor_b32 v2, s11, v121
    v_or_b32 v1, v1, v2
    v_xor_b32 v2, s11, v123
    v_or_b32 v1, v1, v2
    v_xor_b32 v2, s11, v125
    v_or_b32 v1, v1, v2
    v_xor_b32 v2, s11, v127
    v_or_b32 v1, v1, v2
    v_cmpx_ne_u32 vcc, 0, v1
    s_cbranch_execnz L_poll_7
L_polld_8:
    s_nop 2
    s_mov_b64 exec, -1
    v_dot2_f32_bf16 v32, v176, v112, 0
    v_dot2_f32_bf16 v33, v177, v112, 0
    v_dot2_f32_bf16 v34, v178, v112, 0
    v_dot2_f32_bf16 v35, v179, v112, 0
    v_dot2_f32_bf16 v36, v180, v112, 0
    v_dot2_f32_bf16 v37, v181, v112, 0
    v_dot2_f32_bf16 v38, v182, v112, 0
    v_dot2_f32_bf16 v39, v183, v112, 0
    v_dot2_f32_bf16 v32, v184, v114, v32
    v_dot2_f32_bf16 v33, v185, v114, v33
    v_dot2_f32_bf16 v34, v186, v114, v34
    v_dot2_f32_bf16 v35, v187, v114, v35
    v_dot2_f32_bf16 v36, v188, v114, v36
    v_dot2_f32_bf16 v37, v189, v114, v37
    v_dot2_f32_bf16 v38, v190, v114, v38
    v_dot2_f32_bf16 v39, v191, v114, v39
    v_dot2_f32_bf16 v32, v192, v116, v32
    v_dot2_f32_bf16 v33, v193, v116, v33
    v_dot2_f32_bf16 v34, v194, v116, v34
    v_dot2_f32_bf16 v35, v195, v116, v35
    v_dot2_f32_bf16 v36, v196, v116, v36
    v_dot2_f32_bf16 v37, v197, v116, v37
    v_dot2_f32_bf16 v38, v198, v116, v38
    v_dot2_f32_bf16 v39, v199, v116, v39
    v_dot2_f32_bf16 v32, v200, v118, v32
    v_dot2_f32_bf16 v33, v201, v118, v33
    v_dot2_f32_bf16 v34, v202, v118, v34
    v_dot2_f32_bf16 v35, v203, v118, v35
    v_dot2_f32_bf16 v36, v204, v118, v36
    v_dot2_f32_bf16 v37, v205, v118, v37
    v_dot2_f32_bf16 v38, v206, v118, v38
    v_dot2_f32_bf16 v39, v207, v118, v39
    v_dot2_f32_bf16 v32, v208, v120, v32
    v_dot2_f32_bf16 v33, v209, v120, v33
    v_dot2_f32_bf16 v34, v210, v120, v34
    v_dot2_f32_bf16 v35, v211, v120, v35
    v_dot2_f32_bf16 v36, v212, v120, v36
    v_dot2_f32_bf16 v37, v213, v120, v37
    v_dot2_f32_bf16 v38, v214, v120, v38
    v_dot2_f32_bf16 v39, v215, v120, v39
    v_dot2_f32_bf16 v32, v216, v122, v32
    v_dot2_f32_bf16 v33, v217, v122, v33
    v_dot2_f32_bf16 v34, v218, v122, v34
    v_dot2_f32_bf16 v35, v219, v122, v35
    v_dot2_f32_bf16 v36, v220, v122, v36
    v_dot2_f32_bf16 v37, v221, v122, v37
    v_dot2_f32_bf16 v38, v222, v122, v38
    v_dot2_f32_bf16 v39, v223, v122, v39
    v_dot2_f32_bf16 v32, v224, v124, v32
    v_dot2_f32_bf16 v33, v225, v124, v33
    v_dot2_f32_bf16 v34, v226, v124, v34
    v_dot2_f32_bf16 v35, v227, v124, v35
    v_dot2_f32_bf16 v36, v228, v124, v36
    v_dot2_f32_bf16 v37, v229, v124, v37
    v_dot2_f32_bf16 v38, v230, v124, v38
    v_dot2_f32_bf16 v39, v231, v124, v39
    v_dot2_f32_bf16 v32, v232, v126, v32
    v_dot2_f32_bf16 v33, v233, v126, v33
    v_dot2_f32_bf16 v34, v234, v126, v34
    v_dot2_f32_bf16 v35, v235, v126, v35
    v_dot2_f32_bf16 v36, v236, v126, v36
    v_dot2_f32_bf16 v37, v237, v126, v37
    v_dot2_f32_bf16 v38, v238, v126, v38
    v_dot2_f32_bf16 v39, v239, v126, v39
    s_nop 2
    v_permlane32_swap_b32 v32, v36
    v_permlane32_swap_b32 v33, v37
    v_permlane32_swap_b32 v34, v38
    v_permlane32_swap_b32 v35, v39
    s_nop 0
    v_add_f32 v32, v32, v36
    v_add_f32 v33, v33, v37
    v_add_f32 v34, v34, v38
    v_add_f32 v35, v35, v39
    s_nop 1
    v_permlane16_swap_b32 v32, v34
    v_permlane16_swap_b32 v33, v35
    s_nop 0
    v_add_f32 v32, v32, v34
    v_add_f32 v33, v33, v35
    v_and_b32 v1, 15, v0
    v_lshlrev_b32 v1, 2, v1
    v_lshrrev_b32 v2, 4, v0
    v_add_u32 v1, v1, v2
    v_lshlrev_b32 v1, 3, v1
    s_lshl_b32 s6, s3, 11
    v_add_u32 v1, s6, v1
    ds_write_b64 v1, v[32:33] offset:1024
    s_waitcnt lgkmcnt(0)
    s_barrier
    v_lshlrev_b32 v1, 3, v0
    ds_read_b64 v[16:17], v1 offset:1024
    ds_read_b64 v[18:19], v1 offset:3072
    ds_read_b64 v[20:21], v1 offset:5120
    ds_read_b64 v[22:23], v1 offset:7168
    ds_read_b64 v[24:25], v1 offset:9216
    ds_read_b64 v[26:27], v1 offset:11264
    ds_read_b64 v[28:29], v1 offset:13312
    ds_read_b64 v[30:31], v1 offset:15360
    v_add_u32 v1, 0x110000, v1
    s_lshl_b32 s6, s4, 3
    s_add_u32 s6, s6, s3
    s_lshl_b32 s6, s6, 9
    s_waitcnt lgkmcnt(0)
    v_add_f32 v16, v16, v24
    v_add_f32 v17, v17, v25
    v_add_f32 v18, v18, v26
    v_add_f32 v19, v19, v27
    v_add_f32 v20, v20, v28
    v_add_f32 v21, v21, v29
    v_add_f32 v22, v22, v30
    v_add_f32 v23, v23, v31
    v_add_f32 v16, v16, v20
    v_add_f32 v17, v17, v21
    v_add_f32 v18, v18, v22
    v_add_f32 v19, v19, v23
    v_add_f32 v16, v16, v18
    v_add_f32 v17, v17, v19
    v_cvt_pk_bf16_f32 v18, v16, v17
    v_mov_b32 v19, s11
    buffer_store_dwordx2 v[18:19], v1, s[28:31], s6 offen sc1
    v_lshrrev_b32 v3, 1, v0
    v_and_b32 v2, 1, v0
    v_lshlrev_b32 v2, 4, v2
    s_cmp_eq_u32 s60, -1
    s_cbranch_scc1 L_wg_9
    v_mul_u32_u24 v1, 3584, v3
    v_add_u32 v1, v1, v2
    s_lshl_b32 s8, s3, 11
    s_mul_i32 s9, s3, 229376
    s_lshl_b32 s6, s60, 5
    s_add_u32 s9, s6, s9
    s_mov_b32 s6, s9
    s_add_u32 s7, s8, 41984
    s_mov_b32 s32, s80
    s_mov_b32 s33, s81
    s_mov_b32 s34, 0x1c0000
    s_mov_b32 s35, 0x20000
    s_mov_b32 m0, s7
    s_add_u32 s7, s7, 1024
    buffer_load_dwordx4 v1, s[32:35], s6 offen nt lds
    s_add_u32 s6, s6, 114688
    s_mov_b32 m0, s7
    s_add_u32 s7, s7, 1024
    buffer_load_dwordx4 v1, s[32:35], s6 offen nt lds
    s_add_u32 s6, s6, 114688
    s_mov_b32 s6, s9
    s_add_u32 s7, s8, 58368
    s_mov_b32 s32, s82
    s_mov_b32 s33, s83
    s_mov_b32 s34, 0x1c0000
    s_mov_b32 s35, 0x20000
    s_mov_b32 m0, s7
    s_add_u32 s7, s7, 1024
    buffer_load_dwordx4 v1, s[32:35], s6 offen nt lds
    s_add_u32 s6, s6, 114688
    s_mov_b32 m0, s7
    s_add_u32 s7, s7, 1024
    buffer_load_dwordx4 v1, s[32:35], s6 offen nt lds
    s_add_u32 s6, s6, 114688
L_wg_9:
    s_cmp_eq_u32 s61, -1
    s_cbranch_scc1 L_wd_10
    s_cmp_eq_u32 s3, 7
    s_cbranch_scc1 L_wd_10
    s_mov_b32 s32, s84
    s_mov_b32 s33, s85
    s_mov_b32 s34, 0x1c0000
    s_mov_b32 s35, 0x20000
    v_lshl_add_u32 v1, v3, 10, v2
    s_mul_i32 s6, s3, 262144
    s_lshl_b32 s7, s61, 5
    s_add_u32 s6, s6, s7
    s_mul_i32 s7, s3, 8192
    s_add_u32 s7, s7, 41984
    s_mov_b32 m0, s7
    s_add_u32 s7, s7, 1024
    buffer_load_dwordx4 v1, s[32:35], s6 offen nt lds
    s_add_u32 s6, s6, 32768
    s_mov_b32 m0, s7
    s_add_u32 s7, s7, 1024
    buffer_load_dwordx4 v1, s[32:35], s6 offen nt lds
    s_add_u32 s6, s6, 32768
    s_mov_b32 m0, s7
    s_add_u32 s7, s7, 1024
    buffer_load_dwordx4 v1, s[32:35], s6 offen nt lds
    s_add_u32 s6, s6, 32768
    s_mov_b32 m0, s7
    s_add_u32 s7, s7, 1024
    buffer_load_dwordx4 v1, s[32:35], s6 offen nt lds
    s_add_u32 s6, s6, 32768
    s_mov_b32 m0, s7
    s_add_u32 s7, s7, 1024
    buffer_load_dwordx4 v1, s[32:35], s6 offen nt lds
    s_add_u32 s6, s6, 32768
    s_mov_b32 m0, s7
    s_add_u32 s7, s7, 1024
    buffer_load_dwordx4 v1, s[32:35], s6 offen nt lds
    s_add_u32 s6, s6, 32768
    s_mov_b32 m0, s7
    s_add_u32 s7, s7, 1024
    buffer_load_dwordx4 v1, s[32:35], s6 offen nt lds
    s_add_u32 s6, s6, 32768
    s_mov_b32 m0, s7
    s_add_u32 s7, s7, 1024
    buffer_load_dwordx4 v1, s[32:35], s6 offen nt lds
    s_add_u32 s6, s6, 32768
L_wd_10:
    buffer_load_dwordx4 v[48:51], v4, s[16:19], s56 offen offset:0 nt
    buffer_load_dwordx4 v[52:55], v6, s[16:19], s56 offen offset:0 nt
    buffer_load_dwordx4 v[56:59], v4, s[16:19], s56 offen offset:1024 nt
    buffer_load_dwordx4 v[60:63], v6, s[16:19], s56 offen offset:1024 nt
    buffer_load_dwordx4 v[64:67], v4, s[16:19], s56 offen offset:2048 nt
    buffer_load_dwordx4 v[68:71], v6, s[16:19], s56 offen offset:2048 nt
    buffer_load_dwordx4 v[72:75], v4, s[16:19], s56 offen offset:3072 nt
    buffer_load_dwordx4 v[76:79], v6, s[16:19], s56 offen offset:3072 nt
    buffer_load_dwordx4 v[80:83], v5, s[16:19], s56 offen offset:0 nt
    buffer_load_dwordx4 v[84:87], v7, s[16:19], s56 offen offset:0 nt
    buffer_load_dwordx4 v[88:91], v5, s[16:19], s56 offen offset:1024 nt
    buffer_load_dwordx4 v[92:95], v7, s[16:19], s56 offen offset:1024 nt
    buffer_load_dwordx4 v[96:99], v5, s[16:19], s56 offen offset:2048 nt
    buffer_load_dwordx4 v[100:103], v7, s[16:19], s56 offen offset:2048 nt
    buffer_load_dwordx4 v[104:107], v5, s[16:19], s56 offen offset:3072 nt
    buffer_load_dwordx4 v[108:111], v7, s[16:19], s56 offen offset:3072 nt
    v_and_b32 v3, 15, v0
    v_lshlrev_b32 v3, 5, v3
    v_add_u32 v3, 0x110000, v3
    s_lshl_b32 s8, s2, 9
    s_branch L_qpoll
L_prefetch:
    v_lshrrev_b32 v3, 1, v0
    v_and_b32 v2, 1, v0
    v_lshlrev_b32 v2, 4, v2
    s_cmp_eq_u32 s60, -1
    s_cbranch_scc1 L_wg_11
    v_mul_u32_u24 v1, 3584, v3
    v_add_u32 v1, v1, v2
    s_lshl_b32 s8, s3, 11
    s_mul_i32 s9, s3, 229376
    s_lshl_b32 s6, s60, 5
    s_add_u32 s9, s6, s9
    s_mov_b32 s6, s9
    s_add_u32 s7, s8, 41984
    s_mov_b32 s32, s80
    s_mov_b32 s33, s81
    s_mov_b32 s34, 0x1c0000
    s_mov_b32 s35, 0x20000
    s_mov_b32 m0, s7
    s_add_u32 s7, s7, 1024
    buffer_load_dwordx4 v1, s[32:35], s6 offen nt lds
    s_add_u32 s6, s6, 114688
    s_mov_b32 m0, s7
    s_add_u32 s7, s7, 1024
    buffer_load_dwordx4 v1, s[32:35], s6 offen nt lds
    s_add_u32 s6, s6, 114688
    s_mov_b32 s6, s9
    s_add_u32 s7, s8, 58368
    s_mov_b32 s32, s82
    s_mov_b32 s33, s83
    s_mov_b32 s34, 0x1c0000
    s_mov_b32 s35, 0x20000
    s_mov_b32 m0, s7
    s_add_u32 s7, s7, 1024
    buffer_load_dwordx4 v1, s[32:35], s6 offen nt lds
    s_add_u32 s6, s6, 114688
    s_mov_b32 m0, s7
    s_add_u32 s7, s7, 1024
    buffer_load_dwordx4 v1, s[32:35], s6 offen nt lds
    s_add_u32 s6, s6, 114688
L_wg_11:
    s_cmp_eq_u32 s61, -1
    s_cbranch_scc1 L_wd_12
    s_cmp_eq_u32 s3, 7
    s_cbranch_scc1 L_wd_12
    s_mov_b32 s32, s84
    s_mov_b32 s33, s85
    s_mov_b32 s34, 0x1c0000
    s_mov_b32 s35, 0x20000
    v_lshl_add_u32 v1, v3, 10, v2
    s_mul_i32 s6, s3, 262144
    s_lshl_b32 s7, s61, 5
    s_add_u32 s6, s6, s7
    s_mul_i32 s7, s3, 8192
    s_add_u32 s7, s7, 41984
    s_mov_b32 m0, s7
    s_add_u32 s7, s7, 1024
    buffer_load_dwordx4 v1, s[32:35], s6 offen nt lds
    s_add_u32 s6, s6, 32768
    s_mov_b32 m0, s7
    s_add_u32 s7, s7, 1024
    buffer_load_dwordx4 v1, s[32:35], s6 offen nt lds
    s_add_u32 s6, s6, 32768
    s_mov_b32 m0, s7
    s_add_u32 s7, s7, 1024
    buffer_load_dwordx4 v1, s[32:35], s6 offen nt lds
    s_add_u32 s6, s6, 32768
    s_mov_b32 m0, s7
    s_add_u32 s7, s7, 1024
    buffer_load_dwordx4 v1, s[32:35], s6 offen nt lds
    s_add_u32 s6, s6, 32768
    s_mov_b32 m0, s7
    s_add_u32 s7, s7, 1024
    buffer_load_dwordx4 v1, s[32:35], s6 offen nt lds
    s_add_u32 s6, s6, 32768
    s_mov_b32 m0, s7
    s_add_u32 s7, s7, 1024
    buffer_load_dwordx4 v1, s[32:35], s6 offen nt lds
    s_add_u32 s6, s6, 32768
    s_mov_b32 m0, s7
    s_add_u32 s7, s7, 1024
    buffer_load_dwordx4 v1, s[32:35], s6 offen nt lds
    s_add_u32 s6, s6, 32768
    s_mov_b32 m0, s7
    s_add_u32 s7, s7, 1024
    buffer_load_dwordx4 v1, s[32:35], s6 offen nt lds
    s_add_u32 s6, s6, 32768
L_wd_12:
    s_waitcnt vmcnt(4)
    buffer_load_dwordx4 v[136:139], v4, s[16:19], s54 offen offset:3072 nt
    buffer_load_dwordx4 v[140:143], v6, s[16:19], s54 offen offset:3072 nt
    s_waitcnt vmcnt(4)
    buffer_load_dwordx4 v[144:147], v5, s[16:19], s54 offen offset:0 nt
    buffer_load_dwordx4 v[148:151], v7, s[16:19], s54 offen offset:0 nt
    s_waitcnt vmcnt(4)
    buffer_load_dwordx4 v[152:155], v5, s[16:19], s54 offen offset:1024 nt
    buffer_load_dwordx4 v[156:159], v7, s[16:19], s54 offen offset:1024 nt
    s_waitcnt vmcnt(4)
    buffer_load_dwordx4 v[160:163], v5, s[16:19], s54 offen offset:2048 nt
    buffer_load_dwordx4 v[164:167], v7, s[16:19], s54 offen offset:2048 nt
    s_waitcnt vmcnt(4)
    buffer_load_dwordx4 v[168:171], v5, s[16:19], s54 offen offset:3072 nt
    buffer_load_dwordx4 v[172:175], v7, s[16:19], s54 offen offset:3072 nt
    s_waitcnt vmcnt(4)
    buffer_load_dwordx4 v[176:179], v4, s[16:19], s55 offen offset:0 nt
    buffer_load_dwordx4 v[180:183], v6, s[16:19], s55 offen offset:0 nt
    s_waitcnt vmcnt(4)
    buffer_load_dwordx4 v[184:187], v4, s[16:19], s55 offen offset:1024 nt
    buffer_load_dwordx4 v[188:191], v6, s[16:19], s55 offen offset:1024 nt
    s_waitcnt vmcnt(4)
    buffer_load_dwordx4 v[192:195], v4, s[16:19], s55 offen offset:2048 nt
    buffer_load_dwordx4 v[196:199], v6, s[16:19], s55 offen offset:2048 nt
    s_waitcnt vmcnt(4)
    buffer_load_dwordx4 v[200:203], v4, s[16:19], s55 offen offset:3072 nt
    buffer_load_dwordx4 v[204:207], v6, s[16:19], s55 offen offset:3072 nt
    s_waitcnt vmcnt(4)
    buffer_load_dwordx4 v[208:211], v5, s[16:19], s55 offen offset:0 nt
    buffer_load_dwordx4 v[212:215], v7, s[16:19], s55 offen offset:0 nt
    s_waitcnt vmcnt(4)
    buffer_load_dwordx4 v[216:219], v5, s[16:19], s55 offen offset:1024 nt
    buffer_load_dwordx4 v[220:223], v7, s[16:19], s55 offen offset:1024 nt
    s_waitcnt vmcnt(4)
    buffer_load_dwordx4 v[224:227], v5, s[16:19], s55 offen offset:2048 nt
    buffer_load_dwordx4 v[228:231], v7, s[16:19], s55 offen offset:2048 nt
    s_waitcnt vmcnt(4)
    buffer_load_dwordx4 v[232:235], v5, s[16:19], s55 offen offset:3072 nt
    buffer_load_dwordx4 v[236:239], v7, s[16:19], s55 offen offset:3072 nt
    s_waitcnt vmcnt(4)
    buffer_load_dwordx4 v[48:51], v4, s[16:19], s56 offen offset:0 nt
    buffer_load_dwordx4 v[52:55], v6, s[16:19], s56 offen offset:0 nt
    s_waitcnt vmcnt(4)
    buffer_load_dwordx4 v[56:59], v4, s[16:19], s56 offen offset:1024 nt
    buffer_load_dwordx4 v[60:63], v6, s[16:19], s56 offen offset:1024 nt
    s_waitcnt vmcnt(4)
    buffer_load_dwordx4 v[64:67], v4, s[16:19], s56 offen offset:2048 nt
    buffer_load_dwordx4 v[68:71], v6, s[16:19], s56 offen offset:2048 nt
    s_waitcnt vmcnt(4)
    buffer_load_dwordx4 v[72:75], v4, s[16:19], s56 offen offset:3072 nt
    buffer_load_dwordx4 v[76:79], v6, s[16:19], s56 offen offset:3072 nt
    s_waitcnt vmcnt(4)
    buffer_load_dwordx4 v[80:83], v5, s[16:19], s56 offen offset:0 nt
    buffer_load_dwordx4 v[84:87], v7, s[16:19], s56 offen offset:0 nt
    s_load_dword s11, s[92:93], 0x0
    s_mov_b32 s52, 0
L_ep_13:
    s_waitcnt lgkmcnt(0)
    s_cmp_lg_u32 s11, 0
    s_cbranch_scc1 L_epd_14
    s_add_u32 s52, s52, 1
    s_cmp_gt_u32 s52, 0x80000
    s_cbranch_scc1 L_end
    s_sleep 4
    s_load_dword s11, s[92:93], 0x0 glc
    s_branch L_ep_13
L_epd_14:
    v_and_b32 v3, 15, v0
    v_lshlrev_b32 v3, 5, v3
    v_add_u32 v3, 0x110000, v3
    s_lshl_b32 s8, s2, 9
    buffer_load_dwordx4 v[16:19], v3, s[28:31], s8 offen offset:0 sc1
    buffer_load_dwordx4 v[20:23], v3, s[28:31], s8 offen offset:16 sc1
    s_waitcnt vmcnt(4)
    buffer_load_dwordx4 v[88:91], v5, s[16:19], s56 offen offset:1024 nt
    buffer_load_dwordx4 v[92:95], v7, s[16:19], s56 offen offset:1024 nt
    s_waitcnt vmcnt(4)
    buffer_load_dwordx4 v[96:99], v5, s[16:19], s56 offen offset:2048 nt
    buffer_load_dwordx4 v[100:103], v7, s[16:19], s56 offen offset:2048 nt
    s_waitcnt vmcnt(4)
    buffer_load_dwordx4 v[104:107], v5, s[16:19], s56 offen offset:3072 nt
    buffer_load_dwordx4 v[108:111], v7, s[16:19], s56 offen offset:3072 nt
    s_waitcnt vmcnt(6)
    v_xor_b32 v1, s11, v17
    v_xor_b32 v2, s11, v19
    v_or_b32 v1, v1, v2
    v_xor_b32 v2, s11, v21
    v_or_b32 v1, v1, v2
    v_xor_b32 v2, s11, v23
    v_or_b32 v1, v1, v2
    v_cmp_ne_u32 vcc, 0, v1
    s_nop 4
    s_cbranch_vccz L_qok
L_qpoll:
    s_mov_b32 s52, 0
L_poll_15:
    buffer_load_dwordx4 v[16:19], v3, s[28:31], s8 offen offset:0 sc1
    buffer_load_dwordx4 v[20:23], v3, s[28:31], s8 offen offset:16 sc1
    s_add_u32 s52, s52, 1
    s_cmp_gt_u32 s52, 0x80000
    s_cbranch_scc1 L_end
    s_waitcnt vmcnt(0)
    v_xor_b32 v1, s11, v17
    v_xor_b32 v2, s11, v19
    v_or_b32 v1, v1, v2
    v_xor_b32 v2, s11, v21
    v_or_b32 v1, v1, v2
    v_xor_b32 v2, s11, v23
    v_or_b32 v1, v1, v2
    v_cmpx_ne_u32 vcc, 0, v1
    s_cbranch_execz L_polld_16
    s_sleep 2
    s_branch L_poll_15
L_polld_16:
    s_nop 2
    s_mov_b64 exec, -1
L_qok:
    v_mov_b32 v8, v16
    v_mov_b32 v9, v18
    v_mov_b32 v10, v20
    v_mov_b32 v11, v22
    v_mov_b32 v32, 0
    v_mov_b32 v33, 0
    v_mov_b32 v34, 0
    v_mov_b32 v35, 0
    v_mov_b32 v36, 0
    v_mov_b32 v37, 0
    v_mov_b32 v38, 0
    v_mov_b32 v39, 0
    s_mov_b32 s12, s56
    s_mov_b32 s64, 0x7f000000
    s_mov_b32 s84, 1
    s_lshl_b32 s88, s3, 8
    s_add_u32 s88, s88, 99328
    s_add_u32 s89, s88, 2048
    s_add_u32 s86, s88, 4096
    s_cmp_eq_u32 s53, 0
    s_cselect_b32 s86, s88, s86
    s_mov_b32 s24, s16
    s_mov_b32 s25, s17
    s_mov_b32 s26, 0x1000000
    s_mov_b32 s27, 0x20000
    v_and_b32 v1, 15, v0
    v_lshlrev_b32 v1, 2, v1
    v_lshrrev_b32 v2, 4, v0
    v_add_u32 v1, v1, v2
    v_lshlrev_b32 v1, 3, v1
    s_lshl_b32 s6, s3, 11
    v_add_u32 v251, s6, v1
    s_waitcnt vmcnt(4)
    s_mov_b32 s98, -1
    s_cmp_eq_u32 s62, 0
    s_cbranch_scc1 L_rs_18
    s_mov_b32 s85, 2
    v_mov_b32 v246, 328
    ds_read_b32 v247, v246
    s_waitcnt lgkmcnt(0)
    v_readfirstlane_b32 s6, v247
    s_nop 0
    s_cmp_ge_u32 s6, s97
    s_cbranch_scc1 L_rd_17
L_rs_18:
    v_mov_b32 v246, 328
    s_mov_b64 exec, 1
    ds_add_rtn_u32 v247, v246, v241
    s_mov_b64 exec, -1
    s_waitcnt lgkmcnt(0)
    v_readfirstlane_b32 s57, v247
    s_nop 0
    s_cmp_ge_u32 s57, 96
    s_cselect_b32 s85, 1, 0
    s_sub_u32 s6, s57, 93
    s_cbranch_scc1 L_rd_17
    s_and_b32 s7, s6, 3
    s_cbranch_scc1 L_rd_17
    s_lshr_b32 s98, s6, 2
    s_cmp_eq_u32 s98, 0
    s_cbranch_scc1 L_ro_20
    s_and_b32 s6, s6, 0x1fc
    s_add_u32 s6, s6, 144892
    v_mov_b32 v246, s6
    s_mov_b32 s52, 0
L_rw_19:
    ds_read_b32 v247, v246
    s_add_u32 s52, s52, 1
    s_cmp_gt_u32 s52, 0x800000
    s_cbranch_scc1 L_end
    s_waitcnt lgkmcnt(0)
    v_readfirstlane_b32 s7, v247
    s_nop 0
    s_cmp_eq_u32 s7, -1
    s_cbranch_scc1 L_rw_19
L_ro_20:
    s_mov_b32 s99, 64
    s_cmp_ge_u32 s98, 20
    s_cbranch_scc1 L_rd_17
    s_mov_b32 s99, 1
    s_atomic_add s99, s[40:41], 0x0 glc
L_rd_17:
    v_dot2_f32_bf16 v16, v48, v8, 0
    v_dot2_f32_bf16 v16, v49, v9, v16
    v_dot2_f32_bf16 v16, v50, v10, v16
    v_dot2_f32_bf16 v16, v51, v11, v16
    v_dot2_f32_bf16 v17, v52, v8, 0
    v_dot2_f32_bf16 v17, v53, v9, v17
    v_dot2_f32_bf16 v17, v54, v10, v17
    v_dot2_f32_bf16 v17, v55, v11, v17
    s_waitcnt vmcnt(4)
    v_dot2_f32_bf16 v18, v56, v8, 0
    v_dot2_f32_bf16 v18, v57, v9, v18
    v_dot2_f32_bf16 v18, v58, v10, v18
    v_dot2_f32_bf16 v18, v59, v11, v18
    v_dot2_f32_bf16 v19, v60, v8, 0
    v_dot2_f32_bf16 v19, v61, v9, v19
    v_dot2_f32_bf16 v19, v62, v10, v19
    v_dot2_f32_bf16 v19, v63, v11, v19
    s_waitcnt vmcnt(4)
    v_dot2_f32_bf16 v20, v64, v8, 0
    v_dot2_f32_bf16 v20, v65, v9, v20
    v_dot2_f32_bf16 v20, v66, v10, v20
    v_dot2_f32_bf16 v20, v67, v11, v20
    v_dot2_f32_bf16 v21, v68, v8, 0
    v_dot2_f32_bf16 v21, v69, v9, v21
    v_dot2_f32_bf16 v21, v70, v10, v21
    v_dot2_f32_bf16 v21, v71, v11, v21
    s_waitcnt vmcnt(4)
    v_dot2_f32_bf16 v22, v72, v8, 0
    v_dot2_f32_bf16 v22, v73, v9, v22
    v_dot2_f32_bf16 v22, v74, v10, v22
    v_dot2_f32_bf16 v22, v75, v11, v22
    v_dot2_f32_bf16 v23, v76, v8, 0
    v_dot2_f32_bf16 v23, v77, v9, v23
    v_dot2_f32_bf16 v23, v78, v10, v23
    v_dot2_f32_bf16 v23, v79, v11, v23
    s_waitcnt vmcnt(4)
    v_dot2_f32_bf16 v24, v80, v8, 0
    v_dot2_f32_bf16 v24, v81, v9, v24
    v_dot2_f32_bf16 v24, v82, v10, v24
    v_dot2_f32_bf16 v24, v83, v11, v24
    v_dot2_f32_bf16 v25, v84, v8, 0
    v_dot2_f32_bf16 v25, v85, v9, v25
    v_dot2_f32_bf16 v25, v86, v10, v25
    v_dot2_f32_bf16 v25, v87, v11, v25
    s_waitcnt vmcnt(4)
    s_cmp_eq_u32 s98, -1
    s_cbranch_scc1 L_du_25
    s_and_b32 s6, s98, 127
    s_lshl2_add_u32 s6, s6, 144896
    v_mov_b32 v246, s6
    s_waitcnt lgkmcnt(0)
    v_mov_b32 v247, s99
    ds_write_b32 v246, v247
L_du_25:
    s_cmp_lg_u32 s85, 0
    s_cbranch_scc1 L_kp_21
L_ko_23:
    s_add_u32 s6, s96, s57
    s_lshr_b32 s7, s6, 2
    s_lshl_b32 s7, s7, 16
    s_and_b32 s13, s6, 3
    s_lshl_b32 s13, s13, 13
    s_or_b32 s13, s13, s7
    s_lshl_b32 s87, s57, 8
    s_add_u32 s87, s87, 99328
    s_cmp_ge_u32 s57, 96
    s_cselect_b32 s13, 0x7f000000, s13
    s_cselect_b32 s87, 144384, s87
    s_branch L_ke_24
L_kp_21:
    s_cmp_eq_u32 s85, 2
    s_cbranch_scc1 L_kv_22
    s_sub_u32 s9, s57, 96
    s_and_b32 s6, s9, 0x1fc
    s_add_u32 s6, s6, 144896
    v_mov_b32 v246, s6
    s_mov_b32 s52, 0
L_rt_26:
    ds_read_b32 v247, v246
    s_add_u32 s52, s52, 1
    s_cmp_gt_u32 s52, 0x800000
    s_cbranch_scc1 L_end
    s_waitcnt lgkmcnt(0)
    v_readfirstlane_b32 s8, v247
    s_nop 0
    s_cmp_eq_u32 s8, -1
    s_cbranch_scc1 L_rt_26
    s_cmp_ge_u32 s8, 64
    s_cbranch_scc1 L_kv_22
    s_and_b32 s9, s9, 3
    s_lshl2_add_u32 s9, s8, s9
    s_mul_i32 s7, s9, 32769
    s_lshr_b32 s7, s7, 20
    s_mul_i32 s7, s7, 96
    s_add_u32 s6, s9, s7
    s_add_u32 s6, s6, 96
    s_lshr_b32 s7, s6, 2
    s_lshl_b32 s7, s7, 16
    s_and_b32 s13, s6, 3
    s_lshl_b32 s13, s13, 13
    s_or_b32 s13, s13, s7
    s_lshl_b32 s87, s57, 8
    s_add_u32 s87, s87, 99328
    s_branch L_ke_24
L_kv_22:
    s_mov_b32 s15, 1
    s_mov_b32 s24, s20
    s_mov_b32 s25, s21
    s_mov_b32 s57, 0x40000000
    s_cmp_lg_u32 s62, 0
    s_cbranch_scc1 L_ko_23
    v_mov_b32 v246, 324
    s_mov_b64 exec, 1
    ds_add_rtn_u32 v247, v246, v241
    s_mov_b64 exec, -1
    s_waitcnt lgkmcnt(0)
    v_readfirstlane_b32 s57, v247
    s_branch L_ko_23
L_ke_24:
    buffer_load_dwordx4 v[48:51], v4, s[24:27], s13 offen offset:0 nt
    buffer_load_dwordx4 v[52:55], v6, s[24:27], s13 offen offset:0 nt
    v_dot2_f32_bf16 v26, v88, v8, 0
    v_dot2_f32_bf16 v26, v89, v9, v26
    v_dot2_f32_bf16 v26, v90, v10, v26
    v_dot2_f32_bf16 v26, v91, v11, v26
    v_dot2_f32_bf16 v27, v92, v8, 0
    v_dot2_f32_bf16 v27, v93, v9, v27
    v_dot2_f32_bf16 v27, v94, v10, v27
    v_dot2_f32_bf16 v27, v95, v11, v27
    s_waitcnt vmcnt(4)
    buffer_load_dwordx4 v[56:59], v4, s[24:27], s13 offen offset:1024 nt
    buffer_load_dwordx4 v[60:63], v6, s[24:27], s13 offen offset:1024 nt
    v_dot2_f32_bf16 v28, v96, v8, 0
    v_dot2_f32_bf16 v28, v97, v9, v28
    v_dot2_f32_bf16 v28, v98, v10, v28
    v_dot2_f32_bf16 v28, v99, v11, v28
    v_dot2_f32_bf16 v29, v100, v8, 0
    v_dot2_f32_bf16 v29, v101, v9, v29
    v_dot2_f32_bf16 v29, v102, v10, v29
    v_dot2_f32_bf16 v29, v103, v11, v29
    s_waitcnt vmcnt(4)
    buffer_load_dwordx4 v[64:67], v4, s[24:27], s13 offen offset:2048 nt
    buffer_load_dwordx4 v[68:71], v6, s[24:27], s13 offen offset:2048 nt
    v_dot2_f32_bf16 v30, v104, v8, 0
    v_dot2_f32_bf16 v30, v105, v9, v30
    v_dot2_f32_bf16 v30, v106, v10, v30
    v_dot2_f32_bf16 v30, v107, v11, v30
    v_dot2_f32_bf16 v31, v108, v8, 0
    v_dot2_f32_bf16 v31, v109, v9, v31
    v_dot2_f32_bf16 v31, v110, v10, v31
    v_dot2_f32_bf16 v31, v111, v11, v31
    s_nop 2
    v_add_f32_dpp v16, v16, v16 row_ror:8 row_mask:0xf bank_mask:0x3
    v_add_f32_dpp v16, v24, v24 row_ror:8 row_mask:0xf bank_mask:0xc
    v_add_f32_dpp v17, v17, v17 row_ror:8 row_mask:0xf bank_mask:0x3
    v_add_f32_dpp v17, v25, v25 row_ror:8 row_mask:0xf bank_mask:0xc
    v_add_f32_dpp v18, v18, v18 row_ror:8 row_mask:0xf bank_mask:0x3
    v_add_f32_dpp v18, v26, v26 row_ror:8 row_mask:0xf bank_mask:0xc
    v_add_f32_dpp v19, v19, v19 row_ror:8 row_mask:0xf bank_mask:0x3
    v_add_f32_dpp v19, v27, v27 row_ror:8 row_mask:0xf bank_mask:0xc
    v_add_f32_dpp v20, v20, v20 row_ror:8 row_mask:0xf bank_mask:0x3
    v_add_f32_dpp v20, v28, v28 row_ror:8 row_mask:0xf bank_mask:0xc
    v_add_f32_dpp v21, v21, v21 row_ror:8 row_mask:0xf bank_mask:0x3
    v_add_f32_dpp v21, v29, v29 row_ror:8 row_mask:0xf bank_mask:0xc
    v_add_f32_dpp v22, v22, v22 row_ror:8 row_mask:0xf bank_mask:0x3
    v_add_f32_dpp v22, v30, v30 row_ror:8 row_mask:0xf bank_mask:0xc
    v_add_f32_dpp v23, v23, v23 row_ror:8 row_mask:0xf bank_mask:0x3
    v_add_f32_dpp v23, v31, v31 row_ror:8 row_mask:0xf bank_mask:0xc
    v_add_f32_dpp v16, v16, v16 row_shl:4 row_mask:0xf bank_mask:0x5
    v_add_f32_dpp v17, v17, v17 row_shl:4 row_mask:0xf bank_mask:0x5
    v_add_f32_dpp v18, v18, v18 row_shl:4 row_mask:0xf bank_mask:0x5
    v_add_f32_dpp v19, v19, v19 row_shl:4 row_mask:0xf bank_mask:0x5
    v_add_f32_dpp v16, v20, v20 row_shr:4 row_mask:0xf bank_mask:0xa
    v_add_f32_dpp v17, v21, v21 row_shr:4 row_mask:0xf bank_mask:0xa
    v_add_f32_dpp v18, v22, v22 row_shr:4 row_mask:0xf bank_mask:0xa
    v_add_f32_dpp v19, v23, v23 row_shr:4 row_mask:0xf bank_mask:0xa
    v_add_f32_dpp v24, v16, v16 quad_perm:[2,3,0,1] row_mask:0xf bank_mask:0xf
    v_add_f32_dpp v25, v18, v18 quad_perm:[2,3,0,1] row_mask:0xf bank_mask:0xf
    v_add_f32_dpp v26, v17, v17 quad_perm:[2,3,0,1] row_mask:0xf bank_mask:0xf
    v_add_f32_dpp v27, v19, v19 quad_perm:[2,3,0,1] row_mask:0xf bank_mask:0xf
    v_cndmask_b32 v16, v24, v25, s[44:45]
    v_cndmask_b32 v17, v26, v27, s[44:45]
    s_nop 1
    v_add_f32_dpp v24, v16, v16 quad_perm:[1,0,3,2] row_mask:0xf bank_mask:0xf
    v_add_f32_dpp v25, v17, v17 quad_perm:[1,0,3,2] row_mask:0xf bank_mask:0xf
    v_cndmask_b32 v16, v24, v25, s[42:43]
    v_cvt_pk_bf16_f32 v16, v16, v16
    v_lshlrev_b32 v16, 16, v16
    v_mul_f32 v16, s47, v16
    v_add_u32 v17, s86, v240
    v_cvt_pk_bf16_f32 v16, v16, v16
    v_lshlrev_b32 v16, 16, v16
    ds_write_b32 v17, v16
    v_max_f32 v18, v12, v16
    v_sub_f32 v19, v12, v18
    v_sub_f32 v20, v16, v18
    v_mul_f32 v19, s46, v19
    v_mul_f32 v20, s46, v20
    v_exp_f32 v19, v19
    v_exp_f32 v20, v20
    v_mov_b32 v12, v18
    s_nop 0
    v_fma_f32 v13, v13, v19, v20
    s_cmp_eq_u32 s53, 0
    s_cbranch_scc1 L_kb_27
    v_dot2_f32_bf16 v16, v112, v8, 0
    v_dot2_f32_bf16 v16, v113, v9, v16
    v_dot2_f32_bf16 v16, v114, v10, v16
    v_dot2_f32_bf16 v16, v115, v11, v16
    v_dot2_f32_bf16 v17, v116, v8, 0
    v_dot2_f32_bf16 v17, v117, v9, v17
    v_dot2_f32_bf16 v17, v118, v10, v17
    v_dot2_f32_bf16 v17, v119, v11, v17
    v_dot2_f32_bf16 v18, v120, v8, 0
    v_dot2_f32_bf16 v18, v121, v9, v18
    v_dot2_f32_bf16 v18, v122, v10, v18
    v_dot2_f32_bf16 v18, v123, v11, v18
    v_dot2_f32_bf16 v19, v124, v8, 0
    v_dot2_f32_bf16 v19, v125, v9, v19
    v_dot2_f32_bf16 v19, v126, v10, v19
    v_dot2_f32_bf16 v19, v127, v11, v19
    v_dot2_f32_bf16 v20, v128, v8, 0
    v_dot2_f32_bf16 v20, v129, v9, v20
    v_dot2_f32_bf16 v20, v130, v10, v20
    v_dot2_f32_bf16 v20, v131, v11, v20
    v_dot2_f32_bf16 v21, v132, v8, 0
    v_dot2_f32_bf16 v21, v133, v9, v21
    v_dot2_f32_bf16 v21, v134, v10, v21
    v_dot2_f32_bf16 v21, v135, v11, v21
    v_dot2_f32_bf16 v22, v136, v8, 0
    v_dot2_f32_bf16 v22, v137, v9, v22
    v_dot2_f32_bf16 v22, v138, v10, v22
    v_dot2_f32_bf16 v22, v139, v11, v22
    v_dot2_f32_bf16 v23, v140, v8, 0
    v_dot2_f32_bf16 v23, v141, v9, v23
    v_dot2_f32_bf16 v23, v142, v10, v23
    v_dot2_f32_bf16 v23, v143, v11, v23
    v_dot2_f32_bf16 v24, v144, v8, 0
    v_dot2_f32_bf16 v24, v145, v9, v24
    v_dot2_f32_bf16 v24, v146, v10, v24
    v_dot2_f32_bf16 v24, v147, v11, v24
    v_dot2_f32_bf16 v25, v148, v8, 0
    v_dot2_f32_bf16 v25, v149, v9, v25
    v_dot2_f32_bf16 v25, v150, v10, v25
    v_dot2_f32_bf16 v25, v151, v11, v25
    v_dot2_f32_bf16 v26, v152, v8, 0
    v_dot2_f32_bf16 v26, v153, v9, v26
    v_dot2_f32_bf16 v26, v154, v10, v26
    v_dot2_f32_bf16 v26, v155, v11, v26
    v_dot2_f32_bf16 v27, v156, v8, 0
    v_dot2_f32_bf16 v27, v157, v9, v27
    v_dot2_f32_bf16 v27, v158, v10, v27
    v_dot2_f32_bf16 v27, v159, v11, v27
    v_dot2_f32_bf16 v28, v160, v8, 0
    v_dot2_f32_bf16 v28, v161, v9, v28
    v_dot2_f32_bf16 v28, v162, v10, v28
    v_dot2_f32_bf16 v28, v163, v11, v28
    v_dot2_f32_bf16 v29, v164, v8, 0
    v_dot2_f32_bf16 v29, v165, v9, v29
    v_dot2_f32_bf16 v29, v166, v10, v29
    v_dot2_f32_bf16 v29, v167, v11, v29
    v_dot2_f32_bf16 v30, v168, v8, 0
    v_dot2_f32_bf16 v30, v169, v9, v30
    v_dot2_f32_bf16 v30, v170, v10, v30
    v_dot2_f32_bf16 v30, v171, v11, v30
    v_dot2_f32_bf16 v31, v172, v8, 0
    v_dot2_f32_bf16 v31, v173, v9, v31
    v_dot2_f32_bf16 v31, v174, v10, v31
    v_dot2_f32_bf16 v31, v175, v11, v31
    s_nop 2
    v_add_f32_dpp v16, v16, v16 row_ror:8 row_mask:0xf bank_mask:0x3
    v_add_f32_dpp v16, v24, v24 row_ror:8 row_mask:0xf bank_mask:0xc
    v_add_f32_dpp v17, v17, v17 row_ror:8 row_mask:0xf bank_mask:0x3
    v_add_f32_dpp v17, v25, v25 row_ror:8 row_mask:0xf bank_mask:0xc
    v_add_f32_dpp v18, v18, v18 row_ror:8 row_mask:0xf bank_mask:0x3
    v_add_f32_dpp v18, v26, v26 row_ror:8 row_mask:0xf bank_mask:0xc
    v_add_f32_dpp v19, v19, v19 row_ror:8 row_mask:0xf bank_mask:0x3
    v_add_f32_dpp v19, v27, v27 row_ror:8 row_mask:0xf bank_mask:0xc
    v_add_f32_dpp v20, v20, v20 row_ror:8 row_mask:0xf bank_mask:0x3
    v_add_f32_dpp v20, v28, v28 row_ror:8 row_mask:0xf bank_mask:0xc
    v_add_f32_dpp v21, v21, v21 row_ror:8 row_mask:0xf bank_mask:0x3
    v_add_f32_dpp v21, v29, v29 row_ror:8 row_mask:0xf bank_mask:0xc
    v_add_f32_dpp v22, v22, v22 row_ror:8 row_mask:0xf bank_mask:0x3
    v_add_f32_dpp v22, v30, v30 row_ror:8 row_mask:0xf bank_mask:0xc
    v_add_f32_dpp v23, v23, v23 row_ror:8 row_mask:0xf bank_mask:0x3
    v_add_f32_dpp v23, v31, v31 row_ror:8 row_mask:0xf bank_mask:0xc
    v_add_f32_dpp v16, v16, v16 row_shl:4 row_mask:0xf bank_mask:0x5
    v_add_f32_dpp v17, v17, v17 row_shl:4 row_mask:0xf bank_mask:0x5
    v_add_f32_dpp v18, v18, v18 row_shl:4 row_mask:0xf bank_mask:0x5
    v_add_f32_dpp v19, v19, v19 row_shl:4 row_mask:0xf bank_mask:0x5
    v_add_f32_dpp v16, v20, v20 row_shr:4 row_mask:0xf bank_mask:0xa
    v_add_f32_dpp v17, v21, v21 row_shr:4 row_mask:0xf bank_mask:0xa
    v_add_f32_dpp v18, v22, v22 row_shr:4 row_mask:0xf bank_mask:0xa
    v_add_f32_dpp v19, v23, v23 row_shr:4 row_mask:0xf bank_mask:0xa
    v_add_f32_dpp v24, v16, v16 quad_perm:[2,3,0,1] row_mask:0xf bank_mask:0xf
    v_add_f32_dpp v25, v18, v18 quad_perm:[2,3,0,1] row_mask:0xf bank_mask:0xf
    v_add_f32_dpp v26, v17, v17 quad_perm:[2,3,0,1] row_mask:0xf bank_mask:0xf
    v_add_f32_dpp v27, v19, v19 quad_perm:[2,3,0,1] row_mask:0xf bank_mask:0xf
    v_cndmask_b32 v16, v24, v25, s[44:45]
    v_cndmask_b32 v17, v26, v27, s[44:45]
    s_nop 1
    v_add_f32_dpp v24, v16, v16 quad_perm:[1,0,3,2] row_mask:0xf bank_mask:0xf
    v_add_f32_dpp v25, v17, v17 quad_perm:[1,0,3,2] row_mask:0xf bank_mask:0xf
    v_cndmask_b32 v16, v24, v25, s[42:43]
    v_cvt_pk_bf16_f32 v16, v16, v16
    v_lshlrev_b32 v16, 16, v16
    v_mul_f32 v16, s47, v16
    v_add_u32 v17, s88, v240
    v_cvt_pk_bf16_f32 v16, v16, v16
    v_lshlrev_b32 v16, 16, v16
    ds_write_b32 v17, v16
    v_max_f32 v18, v12, v16
    v_sub_f32 v19, v12, v18
    v_sub_f32 v20, v16, v18
    v_mul_f32 v19, s46, v19
    v_mul_f32 v20, s46, v20
    v_exp_f32 v19, v19
    v_exp_f32 v20, v20
    v_mov_b32 v12, v18
    s_nop 0
    v_fma_f32 v13, v13, v19, v20
L_kb_27:
    s_mov_b32 s12, s13
    s_mov_b32 s86, s87
    s_cmp_lg_u32 s15, 0
    s_cbranch_scc1 L_k_lastB
    s_waitcnt vmcnt(4)
    buffer_load_dwordx4 v[72:75], v4, s[16:19], s12 offen offset:3072 nt
    buffer_load_dwordx4 v[76:79], v6, s[16:19], s12 offen offset:3072 nt
    s_mov_b32 s98, -1
    s_cmp_eq_u32 s62, 0
    s_cbranch_scc1 L_rs_29
    s_mov_b32 s85, 2
    v_mov_b32 v246, 328
    ds_read_b32 v247, v246
    s_waitcnt lgkmcnt(0)
    v_readfirstlane_b32 s6, v247
    s_nop 0
    s_cmp_ge_u32 s6, s97
    s_cbranch_scc1 L_rd_28
L_rs_29:
    v_mov_b32 v246, 328
    s_mov_b64 exec, 1
    ds_add_rtn_u32 v247, v246, v241
    s_mov_b64 exec, -1
    s_waitcnt lgkmcnt(0)
    v_readfirstlane_b32 s57, v247
    s_nop 0
    s_cmp_ge_u32 s57, 96
    s_cselect_b32 s85, 1, 0
    s_sub_u32 s6, s57, 93
    s_cbranch_scc1 L_rd_28
    s_and_b32 s7, s6, 3
    s_cbranch_scc1 L_rd_28
    s_lshr_b32 s98, s6, 2
    s_cmp_eq_u32 s98, 0
    s_cbranch_scc1 L_ro_31
    s_and_b32 s6, s6, 0x1fc
    s_add_u32 s6, s6, 144892
    v_mov_b32 v246, s6
    s_mov_b32 s52, 0
L_rw_30:
    ds_read_b32 v247, v246
    s_add_u32 s52, s52, 1
    s_cmp_gt_u32 s52, 0x800000
    s_cbranch_scc1 L_end
    s_waitcnt lgkmcnt(0)
    v_readfirstlane_b32 s7, v247
    s_nop 0
    s_cmp_eq_u32 s7, -1
    s_cbranch_scc1 L_rw_30
L_ro_31:
    s_mov_b32 s99, 64
    s_cmp_ge_u32 s98, 20
    s_cbranch_scc1 L_rd_28
    s_mov_b32 s99, 1
    s_atomic_add s99, s[40:41], 0x0 glc
L_rd_28:
    v_dot2_f32_bf16 v16, v48, v8, 0
    v_dot2_f32_bf16 v16, v49, v9, v16
    v_dot2_f32_bf16 v16, v50, v10, v16
    v_dot2_f32_bf16 v16, v51, v11, v16
    v_dot2_f32_bf16 v17, v52, v8, 0
    v_dot2_f32_bf16 v17, v53, v9, v17
    v_dot2_f32_bf16 v17, v54, v10, v17
    v_dot2_f32_bf16 v17, v55, v11, v17
    s_waitcnt vmcnt(4)
    buffer_load_dwordx4 v[80:83], v5, s[16:19], s12 offen offset:0 nt
    buffer_load_dwordx4 v[84:87], v7, s[16:19], s12 offen offset:0 nt
    v_dot2_f32_bf16 v18, v56, v8, 0
    v_dot2_f32_bf16 v18, v57, v9, v18
    v_dot2_f32_bf16 v18, v58, v10, v18
    v_dot2_f32_bf16 v18, v59, v11, v18
    v_dot2_f32_bf16 v19, v60, v8, 0
    v_dot2_f32_bf16 v19, v61, v9, v19
    v_dot2_f32_bf16 v19, v62, v10, v19
    v_dot2_f32_bf16 v19, v63, v11, v19
    s_waitcnt vmcnt(4)
    buffer_load_dwordx4 v[88:91], v5, s[16:19], s12 offen offset:1024 nt
    buffer_load_dwordx4 v[92:95], v7, s[16:19], s12 offen offset:1024 nt
    v_dot2_f32_bf16 v20, v64, v8, 0
    v_dot2_f32_bf16 v20, v65, v9, v20
    v_dot2_f32_bf16 v20, v66, v10, v20
    v_dot2_f32_bf16 v20, v67, v11, v20
    v_dot2_f32_bf16 v21, v68, v8, 0
    v_dot2_f32_bf16 v21, v69, v9, v21
    v_dot2_f32_bf16 v21, v70, v10, v21
    v_dot2_f32_bf16 v21, v71, v11, v21
    s_waitcnt vmcnt(4)
    buffer_load_dwordx4 v[96:99], v5, s[16:19], s12 offen offset:2048 nt
    buffer_load_dwordx4 v[100:103], v7, s[16:19], s12 offen offset:2048 nt
    v_dot2_f32_bf16 v22, v72, v8, 0
    v_dot2_f32_bf16 v22, v73, v9, v22
    v_dot2_f32_bf16 v22, v74, v10, v22
    v_dot2_f32_bf16 v22, v75, v11, v22
    v_dot2_f32_bf16 v23, v76, v8, 0
    v_dot2_f32_bf16 v23, v77, v9, v23
    v_dot2_f32_bf16 v23, v78, v10, v23
    v_dot2_f32_bf16 v23, v79, v11, v23
    s_waitcnt vmcnt(4)
    buffer_load_dwordx4 v[104:107], v5, s[16:19], s12 offen offset:3072 nt
    buffer_load_dwordx4 v[108:111], v7, s[16:19], s12 offen offset:3072 nt
    v_dot2_f32_bf16 v24, v80, v8, 0
    v_dot2_f32_bf16 v24, v81, v9, v24
    v_dot2_f32_bf16 v24, v82, v10, v24
    v_dot2_f32_bf16 v24, v83, v11, v24
    v_dot2_f32_bf16 v25, v84, v8, 0
    v_dot2_f32_bf16 v25, v85, v9, v25
    v_dot2_f32_bf16 v25, v86, v10, v25
    v_dot2_f32_bf16 v25, v87, v11, v25
    s_waitcnt vmcnt(4)
    s_cmp_eq_u32 s98, -1
    s_cbranch_scc1 L_du_36
    s_and_b32 s6, s98, 127
    s_lshl2_add_u32 s6, s6, 144896
    v_mov_b32 v246, s6
    s_waitcnt lgkmcnt(0)
    v_mov_b32 v247, s99
    ds_write_b32 v246, v247
L_du_36:
    s_cmp_lg_u32 s85, 0
    s_cbranch_scc1 L_kp_32
L_ko_34:
    s_add_u32 s6, s96, s57
    s_lshr_b32 s7, s6, 2
    s_lshl_b32 s7, s7, 16
    s_and_b32 s13, s6, 3
    s_lshl_b32 s13, s13, 13
    s_or_b32 s13, s13, s7
    s_lshl_b32 s87, s57, 8
    s_add_u32 s87, s87, 99328
    s_cmp_ge_u32 s57, 96
    s_cselect_b32 s13, 0x7f000000, s13
    s_cselect_b32 s87, 144384, s87
    s_branch L_ke_35
L_kp_32:
    s_cmp_eq_u32 s85, 2
    s_cbranch_scc1 L_kv_33
    s_sub_u32 s9, s57, 96
    s_and_b32 s6, s9, 0x1fc
    s_add_u32 s6, s6, 144896
    v_mov_b32 v246, s6
    s_mov_b32 s52, 0
L_rt_37:
    ds_read_b32 v247, v246
    s_add_u32 s52, s52, 1
    s_cmp_gt_u32 s52, 0x800000
    s_cbranch_scc1 L_end
    s_waitcnt lgkmcnt(0)
    v_readfirstlane_b32 s8, v247
    s_nop 0
    s_cmp_eq_u32 s8, -1
    s_cbranch_scc1 L_rt_37
    s_cmp_ge_u32 s8, 64
    s_cbranch_scc1 L_kv_33
    s_and_b32 s9, s9, 3
    s_lshl2_add_u32 s9, s8, s9
    s_mul_i32 s7, s9, 32769
    s_lshr_b32 s7, s7, 20
    s_mul_i32 s7, s7, 96
    s_add_u32 s6, s9, s7
    s_add_u32 s6, s6, 96
    s_lshr_b32 s7, s6, 2
    s_lshl_b32 s7, s7, 16
    s_and_b32 s13, s6, 3
    s_lshl_b32 s13, s13, 13
    s_or_b32 s13, s13, s7
    s_lshl_b32 s87, s57, 8
    s_add_u32 s87, s87, 99328
    s_branch L_ke_35
L_kv_33:
    s_mov_b32 s15, 1
    s_mov_b32 s24, s20
    s_mov_b32 s25, s21
    s_mov_b32 s57, 0x40000000
    s_cmp_lg_u32 s62, 0
    s_cbranch_scc1 L_ko_34
    v_mov_b32 v246, 324
    s_mov_b64 exec, 1
    ds_add_rtn_u32 v247, v246, v241
    s_mov_b64 exec, -1
    s_waitcnt lgkmcnt(0)
    v_readfirstlane_b32 s57, v247
    s_branch L_ko_34
L_ke_35:
    buffer_load_dwordx4 v[48:51], v4, s[24:27], s13 offen offset:0 nt
    buffer_load_dwordx4 v[52:55], v6, s[24:27], s13 offen offset:0 nt
    v_dot2_f32_bf16 v26, v88, v8, 0
    v_dot2_f32_bf16 v26, v89, v9, v26
    v_dot2_f32_bf16 v26, v90, v10, v26
    v_dot2_f32_bf16 v26, v91, v11, v26
    v_dot2_f32_bf16 v27, v92, v8, 0
    v_dot2_f32_bf16 v27, v93, v9, v27
    v_dot2_f32_bf16 v27, v94, v10, v27
    v_dot2_f32_bf16 v27, v95, v11, v27
    s_waitcnt vmcnt(4)
    buffer_load_dwordx4 v[56:59], v4, s[24:27], s13 offen offset:1024 nt
    buffer_load_dwordx4 v[60:63], v6, s[24:27], s13 offen offset:1024 nt
    v_dot2_f32_bf16 v28, v96, v8, 0
    v_dot2_f32_bf16 v28, v97, v9, v28
    v_dot2_f32_bf16 v28, v98, v10, v28
    v_dot2_f32_bf16 v28, v99, v11, v28
    v_dot2_f32_bf16 v29, v100, v8, 0
    v_dot2_f32_bf16 v29, v101, v9, v29
    v_dot2_f32_bf16 v29, v102, v10, v29
    v_dot2_f32_bf16 v29, v103, v11, v29
    s_waitcnt vmcnt(4)
    buffer_load_dwordx4 v[64:67], v4, s[24:27], s13 offen offset:2048 nt
    buffer_load_dwordx4 v[68:71], v6, s[24:27], s13 offen offset:2048 nt
    v_dot2_f32_bf16 v30, v104, v8, 0
    v_dot2_f32_bf16 v30, v105, v9, v30
    v_dot2_f32_bf16 v30, v106, v10, v30
    v_dot2_f32_bf16 v30, v107, v11, v30
    v_dot2_f32_bf16 v31, v108, v8, 0
    v_dot2_f32_bf16 v31, v109, v9, v31
    v_dot2_f32_bf16 v31, v110, v10, v31
    v_dot2_f32_bf16 v31, v111, v11, v31
    s_nop 2
    v_add_f32_dpp v16, v16, v16 row_ror:8 row_mask:0xf bank_mask:0x3
    v_add_f32_dpp v16, v24, v24 row_ror:8 row_mask:0xf bank_mask:0xc
    v_add_f32_dpp v17, v17, v17 row_ror:8 row_mask:0xf bank_mask:0x3
    v_add_f32_dpp v17, v25, v25 row_ror:8 row_mask:0xf bank_mask:0xc
    v_add_f32_dpp v18, v18, v18 row_ror:8 row_mask:0xf bank_mask:0x3
    v_add_f32_dpp v18, v26, v26 row_ror:8 row_mask:0xf bank_mask:0xc
    v_add_f32_dpp v19, v19, v19 row_ror:8 row_mask:0xf bank_mask:0x3
    v_add_f32_dpp v19, v27, v27 row_ror:8 row_mask:0xf bank_mask:0xc
    v_add_f32_dpp v20, v20, v20 row_ror:8 row_mask:0xf bank_mask:0x3
    v_add_f32_dpp v20, v28, v28 row_ror:8 row_mask:0xf bank_mask:0xc
    v_add_f32_dpp v21, v21, v21 row_ror:8 row_mask:0xf bank_mask:0x3
    v_add_f32_dpp v21, v29, v29 row_ror:8 row_mask:0xf bank_mask:0xc
    v_add_f32_dpp v22, v22, v22 row_ror:8 row_mask:0xf bank_mask:0x3
    v_add_f32_dpp v22, v30, v30 row_ror:8 row_mask:0xf bank_mask:0xc
    v_add_f32_dpp v23, v23, v23 row_ror:8 row_mask:0xf bank_mask:0x3
    v_add_f32_dpp v23, v31, v31 row_ror:8 row_mask:0xf bank_mask:0xc
    v_add_f32_dpp v16, v16, v16 row_shl:4 row_mask:0xf bank_mask:0x5
    v_add_f32_dpp v17, v17, v17 row_shl:4 row_mask:0xf bank_mask:0x5
    v_add_f32_dpp v18, v18, v18 row_shl:4 row_mask:0xf bank_mask:0x5
    v_add_f32_dpp v19, v19, v19 row_shl:4 row_mask:0xf bank_mask:0x5
    v_add_f32_dpp v16, v20, v20 row_shr:4 row_mask:0xf bank_mask:0xa
    v_add_f32_dpp v17, v21, v21 row_shr:4 row_mask:0xf bank_mask:0xa
    v_add_f32_dpp v18, v22, v22 row_shr:4 row_mask:0xf bank_mask:0xa
    v_add_f32_dpp v19, v23, v23 row_shr:4 row_mask:0xf bank_mask:0xa
    v_add_f32_dpp v24, v16, v16 quad_perm:[2,3,0,1] row_mask:0xf bank_mask:0xf
    v_add_f32_dpp v25, v18, v18 quad_perm:[2,3,0,1] row_mask:0xf bank_mask:0xf
    v_add_f32_dpp v26, v17, v17 quad_perm:[2,3,0,1] row_mask:0xf bank_mask:0xf
    v_add_f32_dpp v27, v19, v19 quad_perm:[2,3,0,1] row_mask:0xf bank_mask:0xf
    v_cndmask_b32 v16, v24, v25, s[44:45]
    v_cndmask_b32 v17, v26, v27, s[44:45]
    s_nop 1
    v_add_f32_dpp v24, v16, v16 quad_perm:[1,0,3,2] row_mask:0xf bank_mask:0xf
    v_add_f32_dpp v25, v17, v17 quad_perm:[1,0,3,2] row_mask:0xf bank_mask:0xf
    v_cndmask_b32 v16, v24, v25, s[42:43]
    v_cvt_pk_bf16_f32 v16, v16, v16
    v_lshlrev_b32 v16, 16, v16
    v_mul_f32 v16, s47, v16
    v_add_u32 v17, s86, v240
    v_cvt_pk_bf16_f32 v16, v16, v16
    v_lshlrev_b32 v16, 16, v16
    ds_write_b32 v17, v16
    v_max_f32 v18, v12, v16
    v_sub_f32 v19, v12, v18
    v_sub_f32 v20, v16, v18
    v_mul_f32 v19, s46, v19
    v_mul_f32 v20, s46, v20
    v_exp_f32 v19, v19
    v_exp_f32 v20, v20
    v_mov_b32 v12, v18
    s_nop 0
    v_fma_f32 v13, v13, v19, v20
    s_cmp_eq_u32 s53, 0
    s_cbranch_scc1 L_kb_38
    v_dot2_f32_bf16 v16, v176, v8, 0
    v_dot2_f32_bf16 v16, v177, v9, v16
    v_dot2_f32_bf16 v16, v178, v10, v16
    v_dot2_f32_bf16 v16, v179, v11, v16
    v_dot2_f32_bf16 v17, v180, v8, 0
    v_dot2_f32_bf16 v17, v181, v9, v17
    v_dot2_f32_bf16 v17, v182, v10, v17
    v_dot2_f32_bf16 v17, v183, v11, v17
    v_dot2_f32_bf16 v18, v184, v8, 0
    v_dot2_f32_bf16 v18, v185, v9, v18
    v_dot2_f32_bf16 v18, v186, v10, v18
    v_dot2_f32_bf16 v18, v187, v11, v18
    v_dot2_f32_bf16 v19, v188, v8, 0
    v_dot2_f32_bf16 v19, v189, v9, v19
    v_dot2_f32_bf16 v19, v190, v10, v19
    v_dot2_f32_bf16 v19, v191, v11, v19
    v_dot2_f32_bf16 v20, v192, v8, 0
    v_dot2_f32_bf16 v20, v193, v9, v20
    v_dot2_f32_bf16 v20, v194, v10, v20
    v_dot2_f32_bf16 v20, v195, v11, v20
    v_dot2_f32_bf16 v21, v196, v8, 0
    v_dot2_f32_bf16 v21, v197, v9, v21
    v_dot2_f32_bf16 v21, v198, v10, v21
    v_dot2_f32_bf16 v21, v199, v11, v21
    v_dot2_f32_bf16 v22, v200, v8, 0
    v_dot2_f32_bf16 v22, v201, v9, v22
    v_dot2_f32_bf16 v22, v202, v10, v22
    v_dot2_f32_bf16 v22, v203, v11, v22
    v_dot2_f32_bf16 v23, v204, v8, 0
    v_dot2_f32_bf16 v23, v205, v9, v23
    v_dot2_f32_bf16 v23, v206, v10, v23
    v_dot2_f32_bf16 v23, v207, v11, v23
    v_dot2_f32_bf16 v24, v208, v8, 0
    v_dot2_f32_bf16 v24, v209, v9, v24
    v_dot2_f32_bf16 v24, v210, v10, v24
    v_dot2_f32_bf16 v24, v211, v11, v24
    v_dot2_f32_bf16 v25, v212, v8, 0
    v_dot2_f32_bf16 v25, v213, v9, v25
    v_dot2_f32_bf16 v25, v214, v10, v25
    v_dot2_f32_bf16 v25, v215, v11, v25
    v_dot2_f32_bf16 v26, v216, v8, 0
    v_dot2_f32_bf16 v26, v217, v9, v26
    v_dot2_f32_bf16 v26, v218, v10, v26
    v_dot2_f32_bf16 v26, v219, v11, v26
    v_dot2_f32_bf16 v27, v220, v8, 0
    v_dot2_f32_bf16 v27, v221, v9, v27
    v_dot2_f32_bf16 v27, v222, v10, v27
    v_dot2_f32_bf16 v27, v223, v11, v27
    v_dot2_f32_bf16 v28, v224, v8, 0
    v_dot2_f32_bf16 v28, v225, v9, v28
    v_dot2_f32_bf16 v28, v226, v10, v28
    v_dot2_f32_bf16 v28, v227, v11, v28
    v_dot2_f32_bf16 v29, v228, v8, 0
    v_dot2_f32_bf16 v29, v229, v9, v29
    v_dot2_f32_bf16 v29, v230, v10, v29
    v_dot2_f32_bf16 v29, v231, v11, v29
    v_dot2_f32_bf16 v30, v232, v8, 0
    v_dot2_f32_bf16 v30, v233, v9, v30
    v_dot2_f32_bf16 v30, v234, v10, v30
    v_dot2_f32_bf16 v30, v235, v11, v30
    v_dot2_f32_bf16 v31, v236, v8, 0
    v_dot2_f32_bf16 v31, v237, v9, v31
    v_dot2_f32_bf16 v31, v238, v10, v31
    v_dot2_f32_bf16 v31, v239, v11, v31
    s_nop 2
    v_add_f32_dpp v16, v16, v16 row_ror:8 row_mask:0xf bank_mask:0x3
    v_add_f32_dpp v16, v24, v24 row_ror:8 row_mask:0xf bank_mask:0xc
    v_add_f32_dpp v17, v17, v17 row_ror:8 row_mask:0xf bank_mask:0x3
    v_add_f32_dpp v17, v25, v25 row_ror:8 row_mask:0xf bank_mask:0xc
    v_add_f32_dpp v18, v18, v18 row_ror:8 row_mask:0xf bank_mask:0x3
    v_add_f32_dpp v18, v26, v26 row_ror:8 row_mask:0xf bank_mask:0xc
    v_add_f32_dpp v19, v19, v19 row_ror:8 row_mask:0xf bank_mask:0x3
    v_add_f32_dpp v19, v27, v27 row_ror:8 row_mask:0xf bank_mask:0xc
    v_add_f32_dpp v20, v20, v20 row_ror:8 row_mask:0xf bank_mask:0x3
    v_add_f32_dpp v20, v28, v28 row_ror:8 row_mask:0xf bank_mask:0xc
    v_add_f32_dpp v21, v21, v21 row_ror:8 row_mask:0xf bank_mask:0x3
    v_add_f32_dpp v21, v29, v29 row_ror:8 row_mask:0xf bank_mask:0xc
    v_add_f32_dpp v22, v22, v22 row_ror:8 row_mask:0xf bank_mask:0x3
    v_add_f32_dpp v22, v30, v30 row_ror:8 row_mask:0xf bank_mask:0xc
    v_add_f32_dpp v23, v23, v23 row_ror:8 row_mask:0xf bank_mask:0x3
    v_add_f32_dpp v23, v31, v31 row_ror:8 row_mask:0xf bank_mask:0xc
    v_add_f32_dpp v16, v16, v16 row_shl:4 row_mask:0xf bank_mask:0x5
    v_add_f32_dpp v17, v17, v17 row_shl:4 row_mask:0xf bank_mask:0x5
    v_add_f32_dpp v18, v18, v18 row_shl:4 row_mask:0xf bank_mask:0x5
    v_add_f32_dpp v19, v19, v19 row_shl:4 row_mask:0xf bank_mask:0x5
    v_add_f32_dpp v16, v20, v20 row_shr:4 row_mask:0xf bank_mask:0xa
    v_add_f32_dpp v17, v21, v21 row_shr:4 row_mask:0xf bank_mask:0xa
    v_add_f32_dpp v18, v22, v22 row_shr:4 row_mask:0xf bank_mask:0xa
    v_add_f32_dpp v19, v23, v23 row_shr:4 row_mask:0xf bank_mask:0xa
    v_add_f32_dpp v24, v16, v16 quad_perm:[2,3,0,1] row_mask:0xf bank_mask:0xf
    v_add_f32_dpp v25, v18, v18 quad_perm:[2,3,0,1] row_mask:0xf bank_mask:0xf
    v_add_f32_dpp v26, v17, v17 quad_perm:[2,3,0,1] row_mask:0xf bank_mask:0xf
    v_add_f32_dpp v27, v19, v19 quad_perm:[2,3,0,1] row_mask:0xf bank_mask:0xf
    v_cndmask_b32 v16, v24, v25, s[44:45]
    v_cndmask_b32 v17, v26, v27, s[44:45]
    s_nop 1
    v_add_f32_dpp v24, v16, v16 quad_perm:[1,0,3,2] row_mask:0xf bank_mask:0xf
    v_add_f32_dpp v25, v17, v17 quad_perm:[1,0,3,2] row_mask:0xf bank_mask:0xf
    v_cndmask_b32 v16, v24, v25, s[42:43]
    v_cvt_pk_bf16_f32 v16, v16, v16
    v_lshlrev_b32 v16, 16, v16
    v_mul_f32 v16, s47, v16
    v_add_u32 v17, s89, v240
    v_cvt_pk_bf16_f32 v16, v16, v16
    v_lshlrev_b32 v16, 16, v16
    ds_write_b32 v17, v16
    v_max_f32 v18, v12, v16
    v_sub_f32 v19, v12, v18
    v_sub_f32 v20, v16, v18
    v_mul_f32 v19, s46, v19
    v_mul_f32 v20, s46, v20
    v_exp_f32 v19, v19
    v_exp_f32 v20, v20
    v_mov_b32 v12, v18
    s_nop 0
    v_fma_f32 v13, v13, v19, v20
L_kb_38:
    s_mov_b32 s12, s13
    s_mov_b32 s86, s87
    s_cmp_lg_u32 s15, 0
    s_cbranch_scc1 L_kdone
L_kloop:
    s_waitcnt vmcnt(4)
    buffer_load_dwordx4 v[72:75], v4, s[16:19], s12 offen offset:3072 nt
    buffer_load_dwordx4 v[76:79], v6, s[16:19], s12 offen offset:3072 nt
    s_mov_b32 s98, -1
    s_cmp_eq_u32 s62, 0
    s_cbranch_scc1 L_rs_40
    s_mov_b32 s85, 2
    v_mov_b32 v246, 328
    ds_read_b32 v247, v246
    s_waitcnt lgkmcnt(0)
    v_readfirstlane_b32 s6, v247
    s_nop 0
    s_cmp_ge_u32 s6, s97
    s_cbranch_scc1 L_rd_39
L_rs_40:
    v_mov_b32 v246, 328
    s_mov_b64 exec, 1
    ds_add_rtn_u32 v247, v246, v241
    s_mov_b64 exec, -1
    s_waitcnt lgkmcnt(0)
    v_readfirstlane_b32 s57, v247
    s_nop 0
    s_cmp_ge_u32 s57, 96
    s_cselect_b32 s85, 1, 0
    s_sub_u32 s6, s57, 93
    s_cbranch_scc1 L_rd_39
    s_and_b32 s7, s6, 3
    s_cbranch_scc1 L_rd_39
    s_lshr_b32 s98, s6, 2
    s_cmp_eq_u32 s98, 0
    s_cbranch_scc1 L_ro_42
    s_and_b32 s6, s6, 0x1fc
    s_add_u32 s6, s6, 144892
    v_mov_b32 v246, s6
    s_mov_b32 s52, 0
L_rw_41:
    ds_read_b32 v247, v246
    s_add_u32 s52, s52, 1
    s_cmp_gt_u32 s52, 0x800000
    s_cbranch_scc1 L_end
    s_waitcnt lgkmcnt(0)
    v_readfirstlane_b32 s7, v247
    s_nop 0
    s_cmp_eq_u32 s7, -1
    s_cbranch_scc1 L_rw_41
L_ro_42:
    s_mov_b32 s99, 64
    s_cmp_ge_u32 s98, 20
    s_cbranch_scc1 L_rd_39
    s_mov_b32 s99, 1
    s_atomic_add s99, s[40:41], 0x0 glc
L_rd_39:
    v_dot2_f32_bf16 v16, v48, v8, 0
    v_dot2_f32_bf16 v16, v49, v9, v16
    v_dot2_f32_bf16 v16, v50, v10, v16
    v_dot2_f32_bf16 v16, v51, v11, v16
    v_dot2_f32_bf16 v17, v52, v8, 0
    v_dot2_f32_bf16 v17, v53, v9, v17
    v_dot2_f32_bf16 v17, v54, v10, v17
    v_dot2_f32_bf16 v17, v55, v11, v17
    s_waitcnt vmcnt(4)
    buffer_load_dwordx4 v[80:83], v5, s[16:19], s12 offen offset:0 nt
    buffer_load_dwordx4 v[84:87], v7, s[16:19], s12 offen offset:0 nt
    v_dot2_f32_bf16 v18, v56, v8, 0
    v_dot2_f32_bf16 v18, v57, v9, v18
    v_dot2_f32_bf16 v18, v58, v10, v18
    v_dot2_f32_bf16 v18, v59, v11, v18
    v_dot2_f32_bf16 v19, v60, v8, 0
    v_dot2_f32_bf16 v19, v61, v9, v19
    v_dot2_f32_bf16 v19, v62, v10, v19
    v_dot2_f32_bf16 v19, v63, v11, v19
    s_waitcnt vmcnt(4)
    buffer_load_dwordx4 v[88:91], v5, s[16:19], s12 offen offset:1024 nt
    buffer_load_dwordx4 v[92:95], v7, s[16:19], s12 offen offset:1024 nt
    v_dot2_f32_bf16 v20, v64, v8, 0
    v_dot2_f32_bf16 v20, v65, v9, v20
    v_dot2_f32_bf16 v20, v66, v10, v20
    v_dot2_f32_bf16 v20, v67, v11, v20
    v_dot2_f32_bf16 v21, v68, v8, 0
    v_dot2_f32_bf16 v21, v69, v9, v21
    v_dot2_f32_bf16 v21, v70, v10, v21
    v_dot2_f32_bf16 v21, v71, v11, v21
    s_waitcnt vmcnt(4)
    buffer_load_dwordx4 v[96:99], v5, s[16:19], s12 offen offset:2048 nt
    buffer_load_dwordx4 v[100:103], v7, s[16:19], s12 offen offset:2048 nt
    v_dot2_f32_bf16 v22, v72, v8, 0
    v_dot2_f32_bf16 v22, v73, v9, v22
    v_dot2_f32_bf16 v22, v74, v10, v22
    v_dot2_f32_bf16 v22, v75, v11, v22
    v_dot2_f32_bf16 v23, v76, v8, 0
    v_dot2_f32_bf16 v23, v77, v9, v23
    v_dot2_f32_bf16 v23, v78, v10, v23
    v_dot2_f32_bf16 v23, v79, v11, v23
    s_waitcnt vmcnt(4)
    buffer_load_dwordx4 v[104:107], v5, s[16:19], s12 offen offset:3072 nt
    buffer_load_dwordx4 v[108:111], v7, s[16:19], s12 offen offset:3072 nt
    v_dot2_f32_bf16 v24, v80, v8, 0
    v_dot2_f32_bf16 v24, v81, v9, v24
    v_dot2_f32_bf16 v24, v82, v10, v24
    v_dot2_f32_bf16 v24, v83, v11, v24
    v_dot2_f32_bf16 v25, v84, v8, 0
    v_dot2_f32_bf16 v25, v85, v9, v25
    v_dot2_f32_bf16 v25, v86, v10, v25
    v_dot2_f32_bf16 v25, v87, v11, v25
    s_waitcnt vmcnt(4)
    s_cmp_eq_u32 s98, -1
    s_cbranch_scc1 L_du_47
    s_and_b32 s6, s98, 127
    s_lshl2_add_u32 s6, s6, 144896
    v_mov_b32 v246, s6
    s_waitcnt lgkmcnt(0)
    v_mov_b32 v247, s99
    ds_write_b32 v246, v247
L_du_47:
    s_cmp_lg_u32 s85, 0
    s_cbranch_scc1 L_kp_43
L_ko_45:
    s_add_u32 s6, s96, s57
    s_lshr_b32 s7, s6, 2
    s_lshl_b32 s7, s7, 16
    s_and_b32 s13, s6, 3
    s_lshl_b32 s13, s13, 13
    s_or_b32 s13, s13, s7
    s_lshl_b32 s87, s57, 8
    s_add_u32 s87, s87, 99328
    s_cmp_ge_u32 s57, 96
    s_cselect_b32 s13, 0x7f000000, s13
    s_cselect_b32 s87, 144384, s87
    s_branch L_ke_46
L_kp_43:
    s_cmp_eq_u32 s85, 2
    s_cbranch_scc1 L_kv_44
    s_sub_u32 s9, s57, 96
    s_and_b32 s6, s9, 0x1fc
    s_add_u32 s6, s6, 144896
    v_mov_b32 v246, s6
    s_mov_b32 s52, 0
L_rt_48:
    ds_read_b32 v247, v246
    s_add_u32 s52, s52, 1
    s_cmp_gt_u32 s52, 0x800000
    s_cbranch_scc1 L_end
    s_waitcnt lgkmcnt(0)
    v_readfirstlane_b32 s8, v247
    s_nop 0
    s_cmp_eq_u32 s8, -1
    s_cbranch_scc1 L_rt_48
    s_cmp_ge_u32 s8, 64
    s_cbranch_scc1 L_kv_44
    s_and_b32 s9, s9, 3
    s_lshl2_add_u32 s9, s8, s9
    s_mul_i32 s7, s9, 32769
    s_lshr_b32 s7, s7, 20
    s_mul_i32 s7, s7, 96
    s_add_u32 s6, s9, s7
    s_add_u32 s6, s6, 96
    s_lshr_b32 s7, s6, 2
    s_lshl_b32 s7, s7, 16
    s_and_b32 s13, s6, 3
    s_lshl_b32 s13, s13, 13
    s_or_b32 s13, s13, s7
    s_lshl_b32 s87, s57, 8
    s_add_u32 s87, s87, 99328
    s_branch L_ke_46
L_kv_44:
    s_mov_b32 s15, 1
    s_mov_b32 s24, s20
    s_mov_b32 s25, s21
    s_mov_b32 s57, 0x40000000
    s_cmp_lg_u32 s62, 0
    s_cbranch_scc1 L_ko_45
    v_mov_b32 v246, 324
    s_mov_b64 exec, 1
    ds_add_rtn_u32 v247, v246, v241
    s_mov_b64 exec, -1
    s_waitcnt lgkmcnt(0)
    v_readfirstlane_b32 s57, v247
    s_branch L_ko_45
L_ke_46:
    buffer_load_dwordx4 v[48:51], v4, s[24:27], s13 offen offset:0 nt
    buffer_load_dwordx4 v[52:55], v6, s[24:27], s13 offen offset:0 nt
    v_dot2_f32_bf16 v26, v88, v8, 0
    v_dot2_f32_bf16 v26, v89, v9, v26
    v_dot2_f32_bf16 v26, v90, v10, v26
    v_dot2_f32_bf16 v26, v91, v11, v26
    v_dot2_f32_bf16 v27, v92, v8, 0
    v_dot2_f32_bf16 v27, v93, v9, v27
    v_dot2_f32_bf16 v27, v94, v10, v27
    v_dot2_f32_bf16 v27, v95, v11, v27
    s_waitcnt vmcnt(4)
    buffer_load_dwordx4 v[56:59], v4, s[24:27], s13 offen offset:1024 nt
    buffer_load_dwordx4 v[60:63], v6, s[24:27], s13 offen offset:1024 nt
    v_dot2_f32_bf16 v28, v96, v8, 0
    v_dot2_f32_bf16 v28, v97, v9, v28
    v_dot2_f32_bf16 v28, v98, v10, v28
    v_dot2_f32_bf16 v28, v99, v11, v28
    v_dot2_f32_bf16 v29, v100, v8, 0
    v_dot2_f32_bf16 v29, v101, v9, v29
    v_dot2_f32_bf16 v29, v102, v10, v29
    v_dot2_f32_bf16 v29, v103, v11, v29
    s_waitcnt vmcnt(4)
    buffer_load_dwordx4 v[64:67], v4, s[24:27], s13 offen offset:2048 nt
    buffer_load_dwordx4 v[68:71], v6, s[24:27], s13 offen offset:2048 nt
    v_dot2_f32_bf16 v30, v104, v8, 0
    v_dot2_f32_bf16 v30, v105, v9, v30
    v_dot2_f32_bf16 v30, v106, v10, v30
    v_dot2_f32_bf16 v30, v107, v11, v30
    v_dot2_f32_bf16 v31, v108, v8, 0
    v_dot2_f32_bf16 v31, v109, v9, v31
    v_dot2_f32_bf16 v31, v110, v10, v31
    v_dot2_f32_bf16 v31, v111, v11, v31
    s_nop 2
    v_add_f32_dpp v16, v16, v16 row_ror:8 row_mask:0xf bank_mask:0x3
    v_add_f32_dpp v16, v24, v24 row_ror:8 row_mask:0xf bank_mask:0xc
    v_add_f32_dpp v17, v17, v17 row_ror:8 row_mask:0xf bank_mask:0x3
    v_add_f32_dpp v17, v25, v25 row_ror:8 row_mask:0xf bank_mask:0xc
    v_add_f32_dpp v18, v18, v18 row_ror:8 row_mask:0xf bank_mask:0x3
    v_add_f32_dpp v18, v26, v26 row_ror:8 row_mask:0xf bank_mask:0xc
    v_add_f32_dpp v19, v19, v19 row_ror:8 row_mask:0xf bank_mask:0x3
    v_add_f32_dpp v19, v27, v27 row_ror:8 row_mask:0xf bank_mask:0xc
    v_add_f32_dpp v20, v20, v20 row_ror:8 row_mask:0xf bank_mask:0x3
    v_add_f32_dpp v20, v28, v28 row_ror:8 row_mask:0xf bank_mask:0xc
    v_add_f32_dpp v21, v21, v21 row_ror:8 row_mask:0xf bank_mask:0x3
    v_add_f32_dpp v21, v29, v29 row_ror:8 row_mask:0xf bank_mask:0xc
    v_add_f32_dpp v22, v22, v22 row_ror:8 row_mask:0xf bank_mask:0x3
    v_add_f32_dpp v22, v30, v30 row_ror:8 row_mask:0xf bank_mask:0xc
    v_add_f32_dpp v23, v23, v23 row_ror:8 row_mask:0xf bank_mask:0x3
    v_add_f32_dpp v23, v31, v31 row_ror:8 row_mask:0xf bank_mask:0xc
    v_add_f32_dpp v16, v16, v16 row_shl:4 row_mask:0xf bank_mask:0x5
    v_add_f32_dpp v17, v17, v17 row_shl:4 row_mask:0xf bank_mask:0x5
    v_add_f32_dpp v18, v18, v18 row_shl:4 row_mask:0xf bank_mask:0x5
    v_add_f32_dpp v19, v19, v19 row_shl:4 row_mask:0xf bank_mask:0x5
    v_add_f32_dpp v16, v20, v20 row_shr:4 row_mask:0xf bank_mask:0xa
    v_add_f32_dpp v17, v21, v21 row_shr:4 row_mask:0xf bank_mask:0xa
    v_add_f32_dpp v18, v22, v22 row_shr:4 row_mask:0xf bank_mask:0xa
    v_add_f32_dpp v19, v23, v23 row_shr:4 row_mask:0xf bank_mask:0xa
    v_add_f32_dpp v24, v16, v16 quad_perm:[2,3,0,1] row_mask:0xf bank_mask:0xf
    v_add_f32_dpp v25, v18, v18 quad_perm:[2,3,0,1] row_mask:0xf bank_mask:0xf
    v_add_f32_dpp v26, v17, v17 quad_perm:[2,3,0,1] row_mask:0xf bank_mask:0xf
    v_add_f32_dpp v27, v19, v19 quad_perm:[2,3,0,1] row_mask:0xf bank_mask:0xf
    v_cndmask_b32 v16, v24, v25, s[44:45]
    v_cndmask_b32 v17, v26, v27, s[44:45]
    s_nop 1
    v_add_f32_dpp v24, v16, v16 quad_perm:[1,0,3,2] row_mask:0xf bank_mask:0xf
    v_add_f32_dpp v25, v17, v17 quad_perm:[1,0,3,2] row_mask:0xf bank_mask:0xf
    v_cndmask_b32 v16, v24, v25, s[42:43]
    v_cvt_pk_bf16_f32 v16, v16, v16
    v_lshlrev_b32 v16, 16, v16
    v_mul_f32 v16, s47, v16
    v_add_u32 v17, s86, v240
    v_cvt_pk_bf16_f32 v16, v16, v16
    v_lshlrev_b32 v16, 16, v16
    ds_write_b32 v17, v16
    v_max_f32 v18, v12, v16
    v_sub_f32 v19, v12, v18
    v_sub_f32 v20, v16, v18
    v_mul_f32 v19, s46, v19
    v_mul_f32 v20, s46, v20
    v_exp_f32 v19, v19
    v_exp_f32 v20, v20
    v_mov_b32 v12, v18
    s_nop 0
    v_fma_f32 v13, v13, v19, v20
    s_mov_b32 s12, s13
    s_mov_b32 s86, s87
    s_cmp_eq_u32 s15, 0
    s_cbranch_scc1 L_kloop
    s_branch L_kdone
L_k_lastB:
    s_cmp_eq_u32 s53, 0
    s_cbranch_scc1 L_kb_49
    v_dot2_f32_bf16 v16, v176, v8, 0
    v_dot2_f32_bf16 v16, v177, v9, v16
    v_dot2_f32_bf16 v16, v178, v10, v16
    v_dot2_f32_bf16 v16, v179, v11, v16
    v_dot2_f32_bf16 v17, v180, v8, 0
    v_dot2_f32_bf16 v17, v181, v9, v17
    v_dot2_f32_bf16 v17, v182, v10, v17
    v_dot2_f32_bf16 v17, v183, v11, v17
    v_dot2_f32_bf16 v18, v184, v8, 0
    v_dot2_f32_bf16 v18, v185, v9, v18
    v_dot2_f32_bf16 v18, v186, v10, v18
    v_dot2_f32_bf16 v18, v187, v11, v18
    v_dot2_f32_bf16 v19, v188, v8, 0
    v_dot2_f32_bf16 v19, v189, v9, v19
    v_dot2_f32_bf16 v19, v190, v10, v19
    v_dot2_f32_bf16 v19, v191, v11, v19
    v_dot2_f32_bf16 v20, v192, v8, 0
    v_dot2_f32_bf16 v20, v193, v9, v20
    v_dot2_f32_bf16 v20, v194, v10, v20
    v_dot2_f32_bf16 v20, v195, v11, v20
    v_dot2_f32_bf16 v21, v196, v8, 0
    v_dot2_f32_bf16 v21, v197, v9, v21
    v_dot2_f32_bf16 v21, v198, v10, v21
    v_dot2_f32_bf16 v21, v199, v11, v21
    v_dot2_f32_bf16 v22, v200, v8, 0
    v_dot2_f32_bf16 v22, v201, v9, v22
    v_dot2_f32_bf16 v22, v202, v10, v22
    v_dot2_f32_bf16 v22, v203, v11, v22
    v_dot2_f32_bf16 v23, v204, v8, 0
    v_dot2_f32_bf16 v23, v205, v9, v23
    v_dot2_f32_bf16 v23, v206, v10, v23
    v_dot2_f32_bf16 v23, v207, v11, v23
    v_dot2_f32_bf16 v24, v208, v8, 0
    v_dot2_f32_bf16 v24, v209, v9, v24
    v_dot2_f32_bf16 v24, v210, v10, v24
    v_dot2_f32_bf16 v24, v211, v11, v24
    v_dot2_f32_bf16 v25, v212, v8, 0
    v_dot2_f32_bf16 v25, v213, v9, v25
    v_dot2_f32_bf16 v25, v214, v10, v25
    v_dot2_f32_bf16 v25, v215, v11, v25
    v_dot2_f32_bf16 v26, v216, v8, 0
    v_dot2_f32_bf16 v26, v217, v9, v26
    v_dot2_f32_bf16 v26, v218, v10, v26
    v_dot2_f32_bf16 v26, v219, v11, v26
    v_dot2_f32_bf16 v27, v220, v8, 0
    v_dot2_f32_bf16 v27, v221, v9, v27
    v_dot2_f32_bf16 v27, v222, v10, v27
    v_dot2_f32_bf16 v27, v223, v11, v27
    v_dot2_f32_bf16 v28, v224, v8, 0
    v_dot2_f32_bf16 v28, v225, v9, v28
    v_dot2_f32_bf16 v28, v226, v10, v28
    v_dot2_f32_bf16 v28, v227, v11, v28
    v_dot2_f32_bf16 v29, v228, v8, 0
    v_dot2_f32_bf16 v29, v229, v9, v29
    v_dot2_f32_bf16 v29, v230, v10, v29
    v_dot2_f32_bf16 v29, v231, v11, v29
    v_dot2_f32_bf16 v30, v232, v8, 0
    v_dot2_f32_bf16 v30, v233, v9, v30
    v_dot2_f32_bf16 v30, v234, v10, v30
    v_dot2_f32_bf16 v30, v235, v11, v30
    v_dot2_f32_bf16 v31, v236, v8, 0
    v_dot2_f32_bf16 v31, v237, v9, v31
    v_dot2_f32_bf16 v31, v238, v10, v31
    v_dot2_f32_bf16 v31, v239, v11, v31
    s_nop 2
    v_add_f32_dpp v16, v16, v16 row_ror:8 row_mask:0xf bank_mask:0x3
    v_add_f32_dpp v16, v24, v24 row_ror:8 row_mask:0xf bank_mask:0xc
    v_add_f32_dpp v17, v17, v17 row_ror:8 row_mask:0xf bank_mask:0x3
    v_add_f32_dpp v17, v25, v25 row_ror:8 row_mask:0xf bank_mask:0xc
    v_add_f32_dpp v18, v18, v18 row_ror:8 row_mask:0xf bank_mask:0x3
    v_add_f32_dpp v18, v26, v26 row_ror:8 row_mask:0xf bank_mask:0xc
    v_add_f32_dpp v19, v19, v19 row_ror:8 row_mask:0xf bank_mask:0x3
    v_add_f32_dpp v19, v27, v27 row_ror:8 row_mask:0xf bank_mask:0xc
    v_add_f32_dpp v20, v20, v20 row_ror:8 row_mask:0xf bank_mask:0x3
    v_add_f32_dpp v20, v28, v28 row_ror:8 row_mask:0xf bank_mask:0xc
    v_add_f32_dpp v21, v21, v21 row_ror:8 row_mask:0xf bank_mask:0x3
    v_add_f32_dpp v21, v29, v29 row_ror:8 row_mask:0xf bank_mask:0xc
    v_add_f32_dpp v22, v22, v22 row_ror:8 row_mask:0xf bank_mask:0x3
    v_add_f32_dpp v22, v30, v30 row_ror:8 row_mask:0xf bank_mask:0xc
    v_add_f32_dpp v23, v23, v23 row_ror:8 row_mask:0xf bank_mask:0x3
    v_add_f32_dpp v23, v31, v31 row_ror:8 row_mask:0xf bank_mask:0xc
    v_add_f32_dpp v16, v16, v16 row_shl:4 row_mask:0xf bank_mask:0x5
    v_add_f32_dpp v17, v17, v17 row_shl:4 row_mask:0xf bank_mask:0x5
    v_add_f32_dpp v18, v18, v18 row_shl:4 row_mask:0xf bank_mask:0x5
    v_add_f32_dpp v19, v19, v19 row_shl:4 row_mask:0xf bank_mask:0x5
    v_add_f32_dpp v16, v20, v20 row_shr:4 row_mask:0xf bank_mask:0xa
    v_add_f32_dpp v17, v21, v21 row_shr:4 row_mask:0xf bank_mask:0xa
    v_add_f32_dpp v18, v22, v22 row_shr:4 row_mask:0xf bank_mask:0xa
    v_add_f32_dpp v19, v23, v23 row_shr:4 row_mask:0xf bank_mask:0xa
    v_add_f32_dpp v24, v16, v16 quad_perm:[2,3,0,1] row_mask:0xf bank_mask:0xf
    v_add_f32_dpp v25, v18, v18 quad_perm:[2,3,0,1] row_mask:0xf bank_mask:0xf
    v_add_f32_dpp v26, v17, v17 quad_perm:[2,3,0,1] row_mask:0xf bank_mask:0xf
    v_add_f32_dpp v27, v19, v19 quad_perm:[2,3,0,1] row_mask:0xf bank_mask:0xf
    v_cndmask_b32 v16, v24, v25, s[44:45]
    v_cndmask_b32 v17, v26, v27, s[44:45]
    s_nop 1
    v_add_f32_dpp v24, v16, v16 quad_perm:[1,0,3,2] row_mask:0xf bank_mask:0xf
    v_add_f32_dpp v25, v17, v17 quad_perm:[1,0,3,2] row_mask:0xf bank_mask:0xf
    v_cndmask_b32 v16, v24, v25, s[42:43]
    v_cvt_pk_bf16_f32 v16, v16, v16
    v_lshlrev_b32 v16, 16, v16
    v_mul_f32 v16, s47, v16
    v_add_u32 v17, s89, v240
    v_cvt_pk_bf16_f32 v16, v16, v16
    v_lshlrev_b32 v16, 16, v16
    ds_write_b32 v17, v16
    v_max_f32 v18, v12, v16
    v_sub_f32 v19, v12, v18
    v_sub_f32 v20, v16, v18
    v_mul_f32 v19, s46, v19
    v_mul_f32 v20, s46, v20
    v_exp_f32 v19, v19
    v_exp_f32 v20, v20
    v_mov_b32 v12, v18
    s_nop 0
    v_fma_f32 v13, v13, v19, v20
L_kb_49:
L_kdone:
    s_cmp_eq_u32 s62, 0
    s_cbranch_scc1 L_kdone2
    s_cmp_eq_u32 s97, -1
    s_cbranch_scc1 L_kw2
    s_sub_u32 s6, s3, 5
    s_cmp_gt_u32 s6, 1
    s_cbranch_scc1 L_nocb
    v_lshlrev_b32 v3, 6, v0
    v_add_u32 v3, 0x10000, v3
    s_lshl_b32 s8, s6, 15
    s_lshl_b32 s7, s58, 12
    s_add_u32 s8, s8, s7
    s_lshl_b32 s9, s6, 11
    s_mov_b32 s52, 0
L_poll_50:
    buffer_load_dwordx4 v[16:19], v3, s[28:31], s8 offen offset:0 sc1
    buffer_load_dwordx4 v[20:23], v3, s[28:31], s8 offen offset:16 sc1
    buffer_load_dwordx4 v[24:27], v3, s[28:31], s8 offen offset:32 sc1
    buffer_load_dwordx4 v[28:31], v3, s[28:31], s8 offen offset:48 sc1
    s_add_u32 s52, s52, 1
    s_cmp_gt_u32 s52, 0x80000
    s_cbranch_scc1 L_end
    s_waitcnt vmcnt(0)
    v_xor_b32 v1, s11, v17
    v_xor_b32 v2, s11, v19
    v_or_b32 v1, v1, v2
    v_xor_b32 v2, s11, v21
    v_or_b32 v1, v1, v2
    v_xor_b32 v2, s11, v23
    v_or_b32 v1, v1, v2
    v_xor_b32 v2, s11, v25
    v_or_b32 v1, v1, v2
    v_xor_b32 v2, s11, v27
    v_or_b32 v1, v1, v2
    v_xor_b32 v2, s11, v29
    v_or_b32 v1, v1, v2
    v_xor_b32 v2, s11, v31
    v_or_b32 v1, v1, v2
    v_cmpx_ne_u32 vcc, 0, v1
    s_cbranch_execz L_polld_51
    s_sleep 2
    s_branch L_poll_50
L_polld_51:
    s_nop 2
    s_mov_b64 exec, -1
    v_mov_b32 v17, v18
    v_mov_b32 v21, v22
    v_mov_b32 v25, v26
    v_mov_b32 v29, v30
    v_lshlrev_b32 v3, 5, v0
    v_add_u32 v3, s9, v3
    ds_write_b64 v3, v[16:17] offset:17408
    ds_write_b64 v3, v[20:21] offset:17416
    ds_write_b64 v3, v[24:25] offset:17424
    ds_write_b64 v3, v[28:29] offset:17432
L_nocb:
    v_mov_b32 v3, 332
    s_mov_b32 s52, 0
L_wf_52:
    ds_read_b32 v2, v3
    s_add_u32 s52, s52, 1
    s_cmp_gt_u32 s52, 0x800000
    s_cbranch_scc1 L_end
    s_waitcnt lgkmcnt(0)
    v_readfirstlane_b32 s6, v2
    s_nop 0
    s_cmp_lg_u32 s6, 0
    s_cbranch_scc1 L_wfd_53
    s_sleep 8
    s_branch L_wf_52
L_wfd_53:
    s_and_b32 s6, s6, 1
    s_cbranch_scc1 L_kdone2
    s_mov_b32 s97, -1
    s_mov_b32 s15, 0
    s_mov_b32 s24, s16
    s_mov_b32 s25, s17
    s_mov_b32 s98, -1
    s_cmp_eq_u32 s62, 0
    s_cbranch_scc1 L_rs_55
    s_mov_b32 s85, 2
    v_mov_b32 v246, 328
    ds_read_b32 v247, v246
    s_waitcnt lgkmcnt(0)
    v_readfirstlane_b32 s6, v247
    s_nop 0
    s_cmp_ge_u32 s6, s97
    s_cbranch_scc1 L_rd_54
L_rs_55:
    v_mov_b32 v246, 328
    s_mov_b64 exec, 1
    ds_add_rtn_u32 v247, v246, v241
    s_mov_b64 exec, -1
    s_waitcnt lgkmcnt(0)
    v_readfirstlane_b32 s57, v247
    s_nop 0
    s_cmp_ge_u32 s57, 96
    s_cselect_b32 s85, 1, 0
    s_sub_u32 s6, s57, 93
    s_cbranch_scc1 L_rd_54
    s_and_b32 s7, s6, 3
    s_cbranch_scc1 L_rd_54
    s_lshr_b32 s98, s6, 2
    s_cmp_eq_u32 s98, 0
    s_cbranch_scc1 L_ro_57
    s_and_b32 s6, s6, 0x1fc
    s_add_u32 s6, s6, 144892
    v_mov_b32 v246, s6
    s_mov_b32 s52, 0
L_rw_56:
    ds_read_b32 v247, v246
    s_add_u32 s52, s52, 1
    s_cmp_gt_u32 s52, 0x800000
    s_cbranch_scc1 L_end
    s_waitcnt lgkmcnt(0)
    v_readfirstlane_b32 s7, v247
    s_nop 0
    s_cmp_eq_u32 s7, -1
    s_cbranch_scc1 L_rw_56
L_ro_57:
    s_mov_b32 s99, 64
    s_cmp_ge_u32 s98, 20
    s_cbranch_scc1 L_rd_54
    s_mov_b32 s99, 1
    s_atomic_add s99, s[40:41], 0x0 glc
L_rd_54:
    s_cmp_eq_u32 s98, -1
    s_cbranch_scc1 L_du_62
    s_and_b32 s6, s98, 127
    s_lshl2_add_u32 s6, s6, 144896
    v_mov_b32 v246, s6
    s_waitcnt lgkmcnt(0)
    v_mov_b32 v247, s99
    ds_write_b32 v246, v247
L_du_62:
    s_cmp_lg_u32 s85, 0
    s_cbranch_scc1 L_kp_58
L_ko_60:
    s_add_u32 s6, s96, s57
    s_lshr_b32 s7, s6, 2
    s_lshl_b32 s7, s7, 16
    s_and_b32 s13, s6, 3
    s_lshl_b32 s13, s13, 13
    s_or_b32 s13, s13, s7
    s_lshl_b32 s87, s57, 8
    s_add_u32 s87, s87, 99328
    s_cmp_ge_u32 s57, 96
    s_cselect_b32 s13, 0x7f000000, s13
    s_cselect_b32 s87, 144384, s87
    s_branch L_ke_61
L_kp_58:
    s_cmp_eq_u32 s85, 2
    s_cbranch_scc1 L_kv_59
    s_sub_u32 s9, s57, 96
    s_and_b32 s6, s9, 0x1fc
    s_add_u32 s6, s6, 144896
    v_mov_b32 v246, s6
    s_mov_b32 s52, 0
L_rt_63:
    ds_read_b32 v247, v246
    s_add_u32 s52, s52, 1
    s_cmp_gt_u32 s52, 0x800000
    s_cbranch_scc1 L_end
    s_waitcnt lgkmcnt(0)
    v_readfirstlane_b32 s8, v247
    s_nop 0
    s_cmp_eq_u32 s8, -1
    s_cbranch_scc1 L_rt_63
    s_cmp_ge_u32 s8, 64
    s_cbranch_scc1 L_kv_59
    s_and_b32 s9, s9, 3
    s_lshl2_add_u32 s9, s8, s9
    s_mul_i32 s7, s9, 32769
    s_lshr_b32 s7, s7, 20
    s_mul_i32 s7, s7, 96
    s_add_u32 s6, s9, s7
    s_add_u32 s6, s6, 96
    s_lshr_b32 s7, s6, 2
    s_lshl_b32 s7, s7, 16
    s_and_b32 s13, s6, 3
    s_lshl_b32 s13, s13, 13
    s_or_b32 s13, s13, s7
    s_lshl_b32 s87, s57, 8
    s_add_u32 s87, s87, 99328
    s_branch L_ke_61
L_kv_59:
    s_mov_b32 s15, 1
    s_mov_b32 s24, s20
    s_mov_b32 s25, s21
    s_mov_b32 s57, 0x40000000
    s_cmp_lg_u32 s62, 0
    s_cbranch_scc1 L_ko_60
    v_mov_b32 v246, 324
    s_mov_b64 exec, 1
    ds_add_rtn_u32 v247, v246, v241
    s_mov_b64 exec, -1
    s_waitcnt lgkmcnt(0)
    v_readfirstlane_b32 s57, v247
    s_branch L_ko_60
L_ke_61:
    s_cmp_lg_u32 s15, 0
    s_cbranch_scc1 L_kw2
    s_mov_b32 s12, s13
    s_mov_b32 s86, s87
    buffer_load_dwordx4 v[48:51], v4, s[16:19], s12 offen offset:0 nt
    buffer_load_dwordx4 v[52:55], v6, s[16:19], s12 offen offset:0 nt
    buffer_load_dwordx4 v[56:59], v4, s[16:19], s12 offen offset:1024 nt
    buffer_load_dwordx4 v[60:63], v6, s[16:19], s12 offen offset:1024 nt
    buffer_load_dwordx4 v[64:67], v4, s[16:19], s12 offen offset:2048 nt
    buffer_load_dwordx4 v[68:71], v6, s[16:19], s12 offen offset:2048 nt
    s_branch L_kloop
L_kw2:
L_kdone2:
    s_mov_b32 s54, 0x7f000000
    s_cmp_lg_u32 s62, 0
    s_cbranch_scc1 L_noke
    v_mov_b32 v246, 332
    v_mov_b32 v247, 1
    ds_or_b32 v246, v247
    v_mov_b32 v246, 324
    v_mov_b32 v247, 2
    s_mov_b64 exec, 1
    ds_add_rtn_u32 v247, v246, v247
    s_mov_b64 exec, -1
    s_waitcnt lgkmcnt(0)
    v_readfirstlane_b32 s8, v247
    s_add_u32 s9, s8, 1
    s_add_u32 s6, s96, s8
    s_lshr_b32 s7, s6, 2
    s_lshl_b32 s7, s7, 16
    s_and_b32 s54, s6, 3
    s_lshl_b32 s54, s54, 13
    s_or_b32 s54, s54, s7
    s_lshl_b32 s88, s8, 8
    s_add_u32 s88, s88, 99328
    s_cmp_ge_u32 s8, 96
    s_cselect_b32 s54, 0x7f000000, s54
    s_cselect_b32 s88, 144384, s88
    s_add_u32 s6, s96, s9
    s_lshr_b32 s7, s6, 2
    s_lshl_b32 s7, s7, 16
    s_and_b32 s55, s6, 3
    s_lshl_b32 s55, s55, 13
    s_or_b32 s55, s55, s7
    s_lshl_b32 s89, s9, 8
    s_add_u32 s89, s89, 99328
    s_cmp_ge_u32 s9, 96
    s_cselect_b32 s55, 0x7f000000, s55
    s_cselect_b32 s89, 144384, s89
L_noke:
    buffer_load_dwordx4 v[112:115], v4, s[20:23], s54 offen offset:0 nt
    buffer_load_dwordx4 v[116:119], v6, s[20:23], s54 offen offset:0 nt
    v_mov_b32 v40, v12
    s_nop 2
    v_max_f32_dpp v40, v40, v40 quad_perm:[1,0,3,2] row_mask:0xf bank_mask:0xf
    s_nop 1
    v_max_f32_dpp v40, v40, v40 quad_perm:[2,3,0,1] row_mask:0xf bank_mask:0xf
    s_nop 1
    v_max_f32_dpp v40, v40, v40 row_ror:4 row_mask:0xf bank_mask:0xf
    s_nop 1
    v_max_f32_dpp v40, v40, v40 row_ror:8 row_mask:0xf bank_mask:0xf
    s_nop 1
    v_mov_b32 v42, v40
    s_nop 1
    v_permlane16_swap_b32 v40, v42
    s_nop 0
    v_max_f32 v40, v40, v42
    v_mov_b32 v42, v40
    s_nop 1
    v_permlane32_swap_b32 v40, v42
    s_nop 0
    v_max_f32 v40, v40, v42
    v_sub_f32 v41, v12, v40
    v_mul_f32 v41, s46, v41
    v_exp_f32 v41, v41
    s_nop 0
    v_mul_f32 v41, v41, v13
    s_nop 2
    v_add_f32_dpp v41, v41, v41 quad_perm:[1,0,3,2] row_mask:0xf bank_mask:0xf
    s_nop 1
    v_add_f32_dpp v41, v41, v41 quad_perm:[2,3,0,1] row_mask:0xf bank_mask:0xf
    s_nop 1
    v_add_f32_dpp v41, v41, v41 row_ror:4 row_mask:0xf bank_mask:0xf
    s_nop 1
    v_add_f32_dpp v41, v41, v41 row_ror:8 row_mask:0xf bank_mask:0xf
    s_nop 1
    v_mov_b32 v42, v41
    s_nop 1
    v_permlane16_swap_b32 v41, v42
    s_nop 0
    v_add_f32 v41, v41, v42
    v_mov_b32 v42, v41
    s_nop 1
    v_permlane32_swap_b32 v41, v42
    s_nop 0
    v_add_f32 v41, v41, v42
    s_lshl_b32 s6, s3, 3
    v_mov_b32 v1, s6
    v_mov_b32 v2, 320
    v_mov_b32 v3, 1
    s_mov_b64 exec, 1
    ds_write_b64 v1, v[40:41] offset:256
    ds_add_rtn_u32 v3, v2, v3
    s_mov_b64 exec, -1
    s_waitcnt lgkmcnt(0)
    v_readfirstlane_b32 s9, v3
    s_nop 1
    s_cmp_lg_u32 s9, 7
    s_cbranch_scc1 L_notlast
    v_and_b32 v3, 7, v0
    v_lshlrev_b32 v1, 3, v3
    ds_read_b64 v[42:43], v1 offset:256
    s_waitcnt lgkmcnt(0)
    v_mov_b32 v44, v42
    s_nop 1
    v_max_f32_dpp v44, v44, v44 quad_perm:[1,0,3,2] row_mask:0xf bank_mask:0xf
    s_nop 1
    v_max_f32_dpp v44, v44, v44 quad_perm:[2,3,0,1] row_mask:0xf bank_mask:0xf
    s_nop 1
    v_max_f32_dpp v44, v44, v44 row_ror:4 row_mask:0xf bank_mask:0xf
    s_nop 1
    v_sub_f32 v46, v42, v44
    v_mul_f32 v46, s46, v46
    v_exp_f32 v46, v46
    s_nop 0
    v_mul_f32 v46, v46, v43
    s_nop 1
    v_add_f32_dpp v46, v46, v46 quad_perm:[1,0,3,2] row_mask:0xf bank_mask:0xf
    s_nop 1
    v_add_f32_dpp v46, v46, v46 quad_perm:[2,3,0,1] row_mask:0xf bank_mask:0xf
    s_nop 1
    v_add_f32_dpp v46, v46, v46 row_ror:4 row_mask:0xf bank_mask:0xf
    s_nop 1
    v_mov_b32 v45, s11
    v_mov_b32 v47, s11
    v_lshlrev_b32 v1, 10, v0
    v_add_u32 v1, 0x50000, v1
    s_lshl_b32 s6, s4, 13
    s_lshl_b32 s7, s5, 7
    s_add_u32 s6, s6, s7
    s_mov_b64 exec, 0xff
    buffer_store_dwordx4 v[44:47], v1, s[28:31], s6 offen sc1
    s_mov_b64 exec, -1
    s_lshl_b32 s6, s2, 10
    s_add_u32 s6, s6, 0x50000
    s_add_u32 s66, s28, s6
    s_addc_u32 s67, s29, 0
    s_mov_b32 s52, 0
L_sp0:
    s_load_dwordx4 s[68:71], s[66:67], 0x0 glc
    s_load_dwordx4 s[72:75], s[66:67], 0x80 glc
    s_load_dwordx4 s[76:79], s[66:67], 0x100 glc
    s_load_dwordx4 s[80:83], s[66:67], 0x180 glc
    s_add_u32 s52, s52, 1
    s_cmp_gt_u32 s52, 0x80000
    s_cbranch_scc1 L_end
    s_waitcnt lgkmcnt(0)
    s_xor_b32 s6, s69, s11
    s_xor_b32 s7, s71, s11
    s_or_b32 s6, s6, s7
    s_xor_b32 s7, s73, s11
    s_or_b32 s6, s6, s7
    s_xor_b32 s7, s75, s11
    s_or_b32 s6, s6, s7
    s_xor_b32 s7, s77, s11
    s_or_b32 s6, s6, s7
    s_xor_b32 s7, s79, s11
    s_or_b32 s6, s6, s7
    s_xor_b32 s7, s81, s11
    s_or_b32 s6, s6, s7
    s_xor_b32 s7, s83, s11
    s_or_b32 s6, s6, s7
    s_cmp_lg_u32 s6, 0
    s_cbranch_scc1 L_sp0
    v_writelane_b32 v16, s68, 0
    v_writelane_b32 v18, s70, 0
    v_writelane_b32 v16, s72, 1
    v_writelane_b32 v18, s74, 1
    v_writelane_b32 v16, s76, 2
    v_writelane_b32 v18, s78, 2
    v_writelane_b32 v16, s80, 3
    v_writelane_b32 v18, s82, 3
L_sp1:
    s_load_dwordx4 s[68:71], s[66:67], 0x200 glc
    s_load_dwordx4 s[72:75], s[66:67], 0x280 glc
    s_load_dwordx4 s[76:79], s[66:67], 0x300 glc
    s_load_dwordx4 s[80:83], s[66:67], 0x380 glc
    s_add_u32 s52, s52, 1
    s_cmp_gt_u32 s52, 0x80000
    s_cbranch_scc1 L_end
    s_waitcnt lgkmcnt(0)
    s_xor_b32 s6, s69, s11
    s_xor_b32 s7, s71, s11
    s_or_b32 s6, s6, s7
    s_xor_b32 s7, s73, s11
    s_or_b32 s6, s6, s7
    s_xor_b32 s7, s75, s11
    s_or_b32 s6, s6, s7
    s_xor_b32 s7, s77, s11
    s_or_b32 s6, s6, s7
    s_xor_b32 s7, s79, s11
    s_or_b32 s6, s6, s7
    s_xor_b32 s7, s81, s11
    s_or_b32 s6, s6, s7
    s_xor_b32 s7, s83, s11
    s_or_b32 s6, s6, s7
    s_cmp_lg_u32 s6, 0
    s_cbranch_scc1 L_sp1
    v_writelane_b32 v16, s68, 4
    v_writelane_b32 v18, s70, 4
    v_writelane_b32 v16, s72, 5
    v_writelane_b32 v18, s74, 5
    v_writelane_b32 v16, s76, 6
    v_writelane_b32 v18, s78, 6
    v_writelane_b32 v16, s80, 7
    v_writelane_b32 v18, s82, 7
    s_nop 0
    v_mov_b32_dpp v16, v16 row_ror:8 row_mask:0xf bank_mask:0xc
    v_mov_b32_dpp v18, v18 row_ror:8 row_mask:0xf bank_mask:0xc
    v_mov_b32 v44, v16
    s_nop 1
    v_max_f32_dpp v44, v44, v44 quad_perm:[1,0,3,2] row_mask:0xf bank_mask:0xf
    s_nop 1
    v_max_f32_dpp v44, v44, v44 quad_perm:[2,3,0,1] row_mask:0xf bank_mask:0xf
    s_nop 1
    v_max_f32_dpp v44, v44, v44 row_ror:4 row_mask:0xf bank_mask:0xf
    s_nop 1
    v_sub_f32 v46, v16, v44
    v_mul_f32 v46, s46, v46
    v_exp_f32 v46, v46
    s_nop 0
    v_mul_f32 v46, v46, v18
    s_nop 1
    v_add_f32_dpp v46, v46, v46 quad_perm:[1,0,3,2] row_mask:0xf bank_mask:0xf
    s_nop 1
    v_add_f32_dpp v46, v46, v46 quad_perm:[2,3,0,1] row_mask:0xf bank_mask:0xf
    s_nop 1
    v_add_f32_dpp v46, v46, v46 row_ror:4 row_mask:0xf bank_mask:0xf
    s_nop 1
    v_rcp_f32 v45, v46
    s_nop 0
    v_fma_f32 v47, -v46, v45, 1.0
    v_fma_f32 v45, v47, v45, v45
    v_mov_b32 v1, 336
    v_mov_b32 v2, 1
    s_mov_b64 exec, 1
    ds_write_b64 v1, v[44:45]
    ds_write_b32 v1, v2 offset:8
    s_mov_b64 exec, -1
L_notlast:
    s_cmp_eq_u32 s62, 0
    s_cbranch_scc1 L_keok
    s_load_dwordx2 s[68:69], s[0:1], 32
    s_load_dwordx4 s[72:75], s[0:1], 48
    s_load_dwordx2 s[70:71], s[0:1], 64
    s_sub_u32 s63, s3, 4
    s_waitcnt lgkmcnt(0)
    v_lshrrev_b32 v3, 1, v0
    v_and_b32 v2, 1, v0
    v_lshlrev_b32 v2, 4, v2
    s_mov_b32 s32, s68
    s_mov_b32 s33, s69
    s_mov_b32 s34, 0x400000
    s_mov_b32 s35, 0x20000
    v_lshrrev_b32 v1, 3, v0
    v_lshlrev_b32 v1, 10, v1
    v_and_b32 v2, 7, v0
    v_lshl_add_u32 v1, v2, 4, v1
    s_lshl_b32 s6, s4, 17
    s_lshl_b32 s7, s5, 7
    s_add_u32 s6, s6, s7
    s_lshl_b32 s7, s63, 15
    s_add_u32 s6, s6, s7
    s_lshl_b32 s7, s63, 12
    s_add_u32 s7, s7, 25600
    s_mov_b32 m0, s7
    s_add_u32 s7, s7, 1024
    buffer_load_dwordx4 v1, s[32:35], s6 offen nt lds
    s_add_u32 s6, s6, 8192
    s_mov_b32 m0, s7
    s_add_u32 s7, s7, 1024
    buffer_load_dwordx4 v1, s[32:35], s6 offen nt lds
    s_add_u32 s6, s6, 8192
    s_mov_b32 m0, s7
    s_add_u32 s7, s7, 1024
    buffer_load_dwordx4 v1, s[32:35], s6 offen nt lds
    s_add_u32 s6, s6, 8192
    s_mov_b32 m0, s7
    s_add_u32 s7, s7, 1024
    buffer_load_dwordx4 v1, s[32:35], s6 offen nt lds
    s_add_u32 s6, s6, 8192
    s_waitcnt vmcnt(0)
    s_branch L_hskip
    v_mov_b32 v246, 324
    v_mov_b32 v247, 3
    s_mov_b64 exec, 1
    ds_add_rtn_u32 v247, v246, v247
    s_mov_b64 exec, -1
    s_waitcnt lgkmcnt(0)
    v_readfirstlane_b32 s8, v247
    s_add_u32 s9, s8, 1
    s_add_u32 s6, s96, s8
    s_lshr_b32 s7, s6, 2
    s_lshl_b32 s7, s7, 16
    s_and_b32 s12, s6, 3
    s_lshl_b32 s12, s12, 13
    s_or_b32 s12, s12, s7
    s_lshl_b32 s86, s8, 8
    s_add_u32 s86, s86, 99328
    s_cmp_ge_u32 s8, 96
    s_cselect_b32 s12, 0x7f000000, s12
    s_cselect_b32 s86, 144384, s86
    s_add_u32 s6, s96, s9
    s_lshr_b32 s7, s6, 2
    s_lshl_b32 s7, s7, 16
    s_and_b32 s54, s6, 3
    s_lshl_b32 s54, s54, 13
    s_or_b32 s54, s54, s7
    s_lshl_b32 s88, s9, 8
    s_add_u32 s88, s88, 99328
    s_cmp_ge_u32 s9, 96
    s_cselect_b32 s54, 0x7f000000, s54
    s_cselect_b32 s88, 144384, s88
    s_add_u32 s9, s9, 1
    s_add_u32 s6, s96, s9
    s_lshr_b32 s7, s6, 2
    s_lshl_b32 s7, s7, 16
    s_and_b32 s55, s6, 3
    s_lshl_b32 s55, s55, 13
    s_or_b32 s55, s55, s7
    s_lshl_b32 s89, s9, 8
    s_add_u32 s89, s89, 99328
    s_cmp_ge_u32 s9, 96
    s_cselect_b32 s55, 0x7f000000, s55
    s_cselect_b32 s89, 144384, s89
    s_waitcnt vmcnt(6)
    buffer_load_dwordx4 v[48:51], v4, s[20:23], s12 offen offset:0 nt
    buffer_load_dwordx4 v[52:55], v6, s[20:23], s12 offen offset:0 nt
    s_waitcnt vmcnt(6)
    buffer_load_dwordx4 v[56:59], v4, s[20:23], s12 offen offset:1024 nt
    buffer_load_dwordx4 v[60:63], v6, s[20:23], s12 offen offset:1024 nt
    s_waitcnt vmcnt(6)
    buffer_load_dwordx4 v[64:67], v4, s[20:23], s12 offen offset:2048 nt
    buffer_load_dwordx4 v[68:71], v6, s[20:23], s12 offen offset:2048 nt
    s_waitcnt vmcnt(6)
    buffer_load_dwordx4 v[112:115], v4, s[20:23], s54 offen offset:0 nt
    buffer_load_dwordx4 v[116:119], v6, s[20:23], s54 offen offset:0 nt
L_keok:
    s_waitcnt vmcnt(6)
    buffer_load_dwordx4 v[120:123], v4, s[20:23], s54 offen offset:1024 nt
    buffer_load_dwordx4 v[124:127], v6, s[20:23], s54 offen offset:1024 nt
    s_waitcnt vmcnt(6)
    buffer_load_dwordx4 v[128:131], v4, s[20:23], s54 offen offset:2048 nt
    buffer_load_dwordx4 v[132:135], v6, s[20:23], s54 offen offset:2048 nt
    s_waitcnt vmcnt(6)
    buffer_load_dwordx4 v[136:139], v4, s[20:23], s54 offen offset:3072 nt
    buffer_load_dwordx4 v[140:143], v6, s[20:23], s54 offen offset:3072 nt
    s_waitcnt vmcnt(6)
    buffer_load_dwordx4 v[144:147], v5, s[20:23], s54 offen offset:0 nt
    buffer_load_dwordx4 v[148:151], v7, s[20:23], s54 offen offset:0 nt
    s_waitcnt vmcnt(6)
    buffer_load_dwordx4 v[152:155], v5, s[20:23], s54 offen offset:1024 nt
    buffer_load_dwordx4 v[156:159], v7, s[20:23], s54 offen offset:1024 nt
    s_waitcnt vmcnt(6)
    buffer_load_dwordx4 v[160:163], v5, s[20:23], s54 offen offset:2048 nt
    buffer_load_dwordx4 v[164:167], v7, s[20:23], s54 offen offset:2048 nt
    s_waitcnt vmcnt(6)
    buffer_load_dwordx4 v[168:171], v5, s[20:23], s54 offen offset:3072 nt
    buffer_load_dwordx4 v[172:175], v7, s[20:23], s54 offen offset:3072 nt
    s_waitcnt vmcnt(6)
    buffer_load_dwordx4 v[176:179], v4, s[20:23], s55 offen offset:0 nt
    buffer_load_dwordx4 v[180:183], v6, s[20:23], s55 offen offset:0 nt
    s_waitcnt vmcnt(6)
    buffer_load_dwordx4 v[184:187], v4, s[20:23], s55 offen offset:1024 nt
    buffer_load_dwordx4 v[188:191], v6, s[20:23], s55 offen offset:1024 nt
    s_waitcnt vmcnt(6)
    buffer_load_dwordx4 v[192:195], v4, s[20:23], s55 offen offset:2048 nt
    buffer_load_dwordx4 v[196:199], v6, s[20:23], s55 offen offset:2048 nt
    s_waitcnt vmcnt(6)
    buffer_load_dwordx4 v[200:203], v4, s[20:23], s55 offen offset:3072 nt
    buffer_load_dwordx4 v[204:207], v6, s[20:23], s55 offen offset:3072 nt
    s_waitcnt vmcnt(6)
    buffer_load_dwordx4 v[208:211], v5, s[20:23], s55 offen offset:0 nt
    buffer_load_dwordx4 v[212:215], v7, s[20:23], s55 offen offset:0 nt
    s_waitcnt vmcnt(6)
    buffer_load_dwordx4 v[216:219], v5, s[20:23], s55 offen offset:1024 nt
    buffer_load_dwordx4 v[220:223], v7, s[20:23], s55 offen offset:1024 nt
    s_waitcnt vmcnt(6)
    buffer_load_dwordx4 v[224:227], v5, s[20:23], s55 offen offset:2048 nt
    buffer_load_dwordx4 v[228:231], v7, s[20:23], s55 offen offset:2048 nt
    s_waitcnt vmcnt(6)
    buffer_load_dwordx4 v[232:235], v5, s[20:23], s55 offen offset:3072 nt
    buffer_load_dwordx4 v[236:239], v7, s[20:23], s55 offen offset:3072 nt
    s_waitcnt vmcnt(6)
    buffer_load_dwordx4 v[72:75], v4, s[20:23], s12 offen offset:3072 nt
    buffer_load_dwordx4 v[76:79], v6, s[20:23], s12 offen offset:3072 nt
    s_waitcnt vmcnt(6)
    buffer_load_dwordx4 v[80:83], v5, s[20:23], s12 offen offset:0 nt
    buffer_load_dwordx4 v[84:87], v7, s[20:23], s12 offen offset:0 nt
    s_waitcnt vmcnt(6)
    buffer_load_dwordx4 v[88:91], v5, s[20:23], s12 offen offset:1024 nt
    buffer_load_dwordx4 v[92:95], v7, s[20:23], s12 offen offset:1024 nt
    s_waitcnt vmcnt(6)
    buffer_load_dwordx4 v[96:99], v5, s[20:23], s12 offen offset:2048 nt
    buffer_load_dwordx4 v[100:103], v7, s[20:23], s12 offen offset:2048 nt
    s_waitcnt vmcnt(6)
    buffer_load_dwordx4 v[104:107], v5, s[20:23], s12 offen offset:3072 nt
    buffer_load_dwordx4 v[108:111], v7, s[20:23], s12 offen offset:3072 nt
L_hskip:
    v_mov_b32 v3, 336
    s_mov_b32 s52, 0
L_fl:
    ds_read_b128 v[40:43], v3
    s_waitcnt lgkmcnt(0)
    v_readfirstlane_b32 s6, v42
    s_add_u32 s52, s52, 1
    s_cmp_lg_u32 s6, 0
    s_cbranch_scc1 L_flok
    s_cmp_gt_u32 s52, 0x800000
    s_cbranch_scc1 L_end
    s_sleep 1
    s_branch L_fl
L_flok:
    s_cmp_lg_u32 s3, 7
    s_cbranch_scc1 L_nosd
    v_lshrrev_b32 v1, 4, v0
    v_lshlrev_b32 v1, 8, v1
    v_and_b32 v2, 15, v0
    v_lshl_add_u32 v1, v2, 4, v1
    v_add_u32 v1, 123904, v1
    v_mov_b32 v2, 144896
    v_lshlrev_b32 v3, 3, v0
    s_mov_b32 s9, 0
L_fls:
    ds_read_b32 v247, v2
    ds_read_b128 v[16:19], v1
    s_waitcnt lgkmcnt(0)
    v_readfirstlane_b32 s8, v247
    v_perm_b32 v20, v17, v16, s49
    v_perm_b32 v21, v19, v18, s49
    s_cmp_ge_u32 s8, 64
    s_cbranch_scc1 L_fle
    s_lshl_b32 s8, s8, 2
    s_mul_i32 s7, s8, 32769
    s_lshr_b32 s7, s7, 20
    s_mul_i32 s7, s7, 96
    s_add_u32 s6, s8, s7
    s_add_u32 s6, s6, 96
    s_lshl_b32 s6, s6, 7
    buffer_store_dwordx2 v[20:21], v3, s[36:39], s6 offen sc1
    v_add_u32 v1, 1024, v1
    v_add_u32 v2, 4, v2
    s_add_u32 s9, s9, 1
    s_cmp_lt_u32 s9, 20
    s_cbranch_scc1 L_fls
L_fle:
    v_lshlrev_b32 v1, 10, v0
    v_add_u32 v1, 0x50040, v1
    v_mov_b32 v2, s11
    s_lshl_b32 s6, s4, 13
    s_lshl_b32 s7, s5, 7
    s_add_u32 s6, s6, s7
    s_waitcnt vmcnt(0)
    s_mov_b64 exec, 0xff
    buffer_store_dword v2, v1, s[28:31], s6 offen sc1
    s_mov_b64 exec, -1
L_nosd:
    v_readfirstlane_b32 s50, v40
    v_readfirstlane_b32 s51, v41
    v_add_u32 v242, s86, v240
    ds_read_b32 v242, v242
    v_mov_b32 v243, 0
    s_mov_b32 s84, 1
    s_mov_b32 s15, 0
    s_mov_b32 s10, 0
    s_cmp_lg_u32 s62, 0
    s_cbranch_scc1 L_vdone
    s_waitcnt vmcnt(4)
    s_waitcnt lgkmcnt(0)
    v_lshl_or_b32 v40, v243, 16, v242
    v_subrev_f32 v40, s50, v40
    v_mul_f32 v40, s46, v40
    v_exp_f32 v40, v40
    s_nop 0
    v_mul_f32 v40, s51, v40
    v_min_f32 v40, 1.0, v40
    v_cvt_pk_bf16_f32 v40, v40, 0
    v_lshlrev_b32 v41, 16, v40
    s_nop 1
    s_mov_b32 s98, -1
    s_cmp_eq_u32 s62, 0
    s_cbranch_scc1 L_rs_67
    s_mov_b32 s85, 2
    s_branch L_rd_66
L_rs_67:
    v_mov_b32 v246, 324
    s_mov_b64 exec, 1
    ds_add_rtn_u32 v247, v246, v241
    s_mov_b64 exec, -1
    s_waitcnt lgkmcnt(0)
    v_readfirstlane_b32 s57, v247
    s_nop 0
    s_cmp_ge_u32 s57, 96
    s_cselect_b32 s85, 1, 0
    s_sub_u32 s6, s57, 93
    s_cbranch_scc1 L_rd_66
    s_and_b32 s7, s6, 3
    s_cbranch_scc1 L_rd_66
    s_lshr_b32 s98, s6, 2
    s_cmp_eq_u32 s98, 0
    s_cbranch_scc1 L_ro_69
    s_and_b32 s6, s6, 0x1fc
    s_add_u32 s6, s6, 145404
    v_mov_b32 v246, s6
    s_mov_b32 s52, 0
L_rw_68:
    ds_read_b32 v247, v246
    s_add_u32 s52, s52, 1
    s_cmp_gt_u32 s52, 0x800000
    s_cbranch_scc1 L_end
    s_waitcnt lgkmcnt(0)
    v_readfirstlane_b32 s7, v247
    s_nop 0
    s_cmp_eq_u32 s7, -1
    s_cbranch_scc1 L_rw_68
L_ro_69:
    s_mov_b32 s99, 1
    s_atomic_add s99, s[40:41], 0x80 glc
L_rd_66:
    v_dot2c_f32_bf16_dpp v32, v40, v48 row_newbcast:0 row_mask:0xf bank_mask:0xf
    v_dot2c_f32_bf16_dpp v33, v41, v48 row_newbcast:0 row_mask:0xf bank_mask:0xf
    v_dot2c_f32_bf16_dpp v34, v40, v49 row_newbcast:0 row_mask:0xf bank_mask:0xf
    v_dot2c_f32_bf16_dpp v35, v41, v49 row_newbcast:0 row_mask:0xf bank_mask:0xf
    v_dot2c_f32_bf16_dpp v36, v40, v50 row_newbcast:0 row_mask:0xf bank_mask:0xf
    v_dot2c_f32_bf16_dpp v37, v41, v50 row_newbcast:0 row_mask:0xf bank_mask:0xf
    v_dot2c_f32_bf16_dpp v38, v40, v51 row_newbcast:0 row_mask:0xf bank_mask:0xf
    v_dot2c_f32_bf16_dpp v39, v41, v51 row_newbcast:0 row_mask:0xf bank_mask:0xf
    v_dot2c_f32_bf16_dpp v32, v40, v52 row_newbcast:1 row_mask:0xf bank_mask:0xf
    v_dot2c_f32_bf16_dpp v33, v41, v52 row_newbcast:1 row_mask:0xf bank_mask:0xf
    v_dot2c_f32_bf16_dpp v34, v40, v53 row_newbcast:1 row_mask:0xf bank_mask:0xf
    v_dot2c_f32_bf16_dpp v35, v41, v53 row_newbcast:1 row_mask:0xf bank_mask:0xf
    v_dot2c_f32_bf16_dpp v36, v40, v54 row_newbcast:1 row_mask:0xf bank_mask:0xf
    v_dot2c_f32_bf16_dpp v37, v41, v54 row_newbcast:1 row_mask:0xf bank_mask:0xf
    v_dot2c_f32_bf16_dpp v38, v40, v55 row_newbcast:1 row_mask:0xf bank_mask:0xf
    v_dot2c_f32_bf16_dpp v39, v41, v55 row_newbcast:1 row_mask:0xf bank_mask:0xf
    s_waitcnt vmcnt(4)
    v_dot2c_f32_bf16_dpp v32, v40, v56 row_newbcast:2 row_mask:0xf bank_mask:0xf
    v_dot2c_f32_bf16_dpp v33, v41, v56 row_newbcast:2 row_mask:0xf bank_mask:0xf
    v_dot2c_f32_bf16_dpp v34, v40, v57 row_newbcast:2 row_mask:0xf bank_mask:0xf
    v_dot2c_f32_bf16_dpp v35, v41, v57 row_newbcast:2 row_mask:0xf bank_mask:0xf
    v_dot2c_f32_bf16_dpp v36, v40, v58 row_newbcast:2 row_mask:0xf bank_mask:0xf
    v_dot2c_f32_bf16_dpp v37, v41, v58 row_newbcast:2 row_mask:0xf bank_mask:0xf
    v_dot2c_f32_bf16_dpp v38, v40, v59 row_newbcast:2 row_mask:0xf bank_mask:0xf
    v_dot2c_f32_bf16_dpp v39, v41, v59 row_newbcast:2 row_mask:0xf bank_mask:0xf
    v_dot2c_f32_bf16_dpp v32, v40, v60 row_newbcast:3 row_mask:0xf bank_mask:0xf
    v_dot2c_f32_bf16_dpp v33, v41, v60 row_newbcast:3 row_mask:0xf bank_mask:0xf
    v_dot2c_f32_bf16_dpp v34, v40, v61 row_newbcast:3 row_mask:0xf bank_mask:0xf
    v_dot2c_f32_bf16_dpp v35, v41, v61 row_newbcast:3 row_mask:0xf bank_mask:0xf
    v_dot2c_f32_bf16_dpp v36, v40, v62 row_newbcast:3 row_mask:0xf bank_mask:0xf
    v_dot2c_f32_bf16_dpp v37, v41, v62 row_newbcast:3 row_mask:0xf bank_mask:0xf
    v_dot2c_f32_bf16_dpp v38, v40, v63 row_newbcast:3 row_mask:0xf bank_mask:0xf
    v_dot2c_f32_bf16_dpp v39, v41, v63 row_newbcast:3 row_mask:0xf bank_mask:0xf
    s_waitcnt vmcnt(4)
    v_dot2c_f32_bf16_dpp v32, v40, v64 row_newbcast:4 row_mask:0xf bank_mask:0xf
    v_dot2c_f32_bf16_dpp v33, v41, v64 row_newbcast:4 row_mask:0xf bank_mask:0xf
    v_dot2c_f32_bf16_dpp v34, v40, v65 row_newbcast:4 row_mask:0xf bank_mask:0xf
    v_dot2c_f32_bf16_dpp v35, v41, v65 row_newbcast:4 row_mask:0xf bank_mask:0xf
    v_dot2c_f32_bf16_dpp v36, v40, v66 row_newbcast:4 row_mask:0xf bank_mask:0xf
    v_dot2c_f32_bf16_dpp v37, v41, v66 row_newbcast:4 row_mask:0xf bank_mask:0xf
    v_dot2c_f32_bf16_dpp v38, v40, v67 row_newbcast:4 row_mask:0xf bank_mask:0xf
    v_dot2c_f32_bf16_dpp v39, v41, v67 row_newbcast:4 row_mask:0xf bank_mask:0xf
    v_dot2c_f32_bf16_dpp v32, v40, v68 row_newbcast:5 row_mask:0xf bank_mask:0xf
    v_dot2c_f32_bf16_dpp v33, v41, v68 row_newbcast:5 row_mask:0xf bank_mask:0xf
    v_dot2c_f32_bf16_dpp v34, v40, v69 row_newbcast:5 row_mask:0xf bank_mask:0xf
    v_dot2c_f32_bf16_dpp v35, v41, v69 row_newbcast:5 row_mask:0xf bank_mask:0xf
    v_dot2c_f32_bf16_dpp v36, v40, v70 row_newbcast:5 row_mask:0xf bank_mask:0xf
    v_dot2c_f32_bf16_dpp v37, v41, v70 row_newbcast:5 row_mask:0xf bank_mask:0xf
    v_dot2c_f32_bf16_dpp v38, v40, v71 row_newbcast:5 row_mask:0xf bank_mask:0xf
    v_dot2c_f32_bf16_dpp v39, v41, v71 row_newbcast:5 row_mask:0xf bank_mask:0xf
    s_waitcnt vmcnt(4)
    v_dot2c_f32_bf16_dpp v32, v40, v72 row_newbcast:6 row_mask:0xf bank_mask:0xf
    v_dot2c_f32_bf16_dpp v33, v41, v72 row_newbcast:6 row_mask:0xf bank_mask:0xf
    v_dot2c_f32_bf16_dpp v34, v40, v73 row_newbcast:6 row_mask:0xf bank_mask:0xf
    v_dot2c_f32_bf16_dpp v35, v41, v73 row_newbcast:6 row_mask:0xf bank_mask:0xf
    v_dot2c_f32_bf16_dpp v36, v40, v74 row_newbcast:6 row_mask:0xf bank_mask:0xf
    v_dot2c_f32_bf16_dpp v37, v41, v74 row_newbcast:6 row_mask:0xf bank_mask:0xf
    v_dot2c_f32_bf16_dpp v38, v40, v75 row_newbcast:6 row_mask:0xf bank_mask:0xf
    v_dot2c_f32_bf16_dpp v39, v41, v75 row_newbcast:6 row_mask:0xf bank_mask:0xf
    v_dot2c_f32_bf16_dpp v32, v40, v76 row_newbcast:7 row_mask:0xf bank_mask:0xf
    v_dot2c_f32_bf16_dpp v33, v41, v76 row_newbcast:7 row_mask:0xf bank_mask:0xf
    v_dot2c_f32_bf16_dpp v34, v40, v77 row_newbcast:7 row_mask:0xf bank_mask:0xf
    v_dot2c_f32_bf16_dpp v35, v41, v77 row_newbcast:7 row_mask:0xf bank_mask:0xf
    v_dot2c_f32_bf16_dpp v36, v40, v78 row_newbcast:7 row_mask:0xf bank_mask:0xf
    v_dot2c_f32_bf16_dpp v37, v41, v78 row_newbcast:7 row_mask:0xf bank_mask:0xf
    v_dot2c_f32_bf16_dpp v38, v40, v79 row_newbcast:7 row_mask:0xf bank_mask:0xf
    v_dot2c_f32_bf16_dpp v39, v41, v79 row_newbcast:7 row_mask:0xf bank_mask:0xf
    v_add_u32 v42, s88, v240
    ds_read_b32 v42, v42
    s_waitcnt lgkmcnt(0)
    v_subrev_f32 v42, s50, v42
    v_mul_f32 v42, s46, v42
    v_exp_f32 v42, v42
    s_nop 0
    v_mul_f32 v42, s51, v42
    v_min_f32 v42, 1.0, v42
    v_cvt_pk_bf16_f32 v42, v42, 0
    v_lshlrev_b32 v43, 16, v42
    s_nop 1
    v_dot2c_f32_bf16_dpp v32, v42, v112 row_newbcast:0 row_mask:0xf bank_mask:0xf
    v_dot2c_f32_bf16_dpp v33, v43, v112 row_newbcast:0 row_mask:0xf bank_mask:0xf
    v_dot2c_f32_bf16_dpp v34, v42, v113 row_newbcast:0 row_mask:0xf bank_mask:0xf
    v_dot2c_f32_bf16_dpp v35, v43, v113 row_newbcast:0 row_mask:0xf bank_mask:0xf
    v_dot2c_f32_bf16_dpp v36, v42, v114 row_newbcast:0 row_mask:0xf bank_mask:0xf
    v_dot2c_f32_bf16_dpp v37, v43, v114 row_newbcast:0 row_mask:0xf bank_mask:0xf
    v_dot2c_f32_bf16_dpp v38, v42, v115 row_newbcast:0 row_mask:0xf bank_mask:0xf
    v_dot2c_f32_bf16_dpp v39, v43, v115 row_newbcast:0 row_mask:0xf bank_mask:0xf
    v_dot2c_f32_bf16_dpp v32, v42, v116 row_newbcast:1 row_mask:0xf bank_mask:0xf
    v_dot2c_f32_bf16_dpp v33, v43, v116 row_newbcast:1 row_mask:0xf bank_mask:0xf
    v_dot2c_f32_bf16_dpp v34, v42, v117 row_newbcast:1 row_mask:0xf bank_mask:0xf
    v_dot2c_f32_bf16_dpp v35, v43, v117 row_newbcast:1 row_mask:0xf bank_mask:0xf
    v_dot2c_f32_bf16_dpp v36, v42, v118 row_newbcast:1 row_mask:0xf bank_mask:0xf
    v_dot2c_f32_bf16_dpp v37, v43, v118 row_newbcast:1 row_mask:0xf bank_mask:0xf
    v_dot2c_f32_bf16_dpp v38, v42, v119 row_newbcast:1 row_mask:0xf bank_mask:0xf
    v_dot2c_f32_bf16_dpp v39, v43, v119 row_newbcast:1 row_mask:0xf bank_mask:0xf
    v_dot2c_f32_bf16_dpp v32, v42, v120 row_newbcast:2 row_mask:0xf bank_mask:0xf
    v_dot2c_f32_bf16_dpp v33, v43, v120 row_newbcast:2 row_mask:0xf bank_mask:0xf
    v_dot2c_f32_bf16_dpp v34, v42, v121 row_newbcast:2 row_mask:0xf bank_mask:0xf
    v_dot2c_f32_bf16_dpp v35, v43, v121 row_newbcast:2 row_mask:0xf bank_mask:0xf
    v_dot2c_f32_bf16_dpp v36, v42, v122 row_newbcast:2 row_mask:0xf bank_mask:0xf
    v_dot2c_f32_bf16_dpp v37, v43, v122 row_newbcast:2 row_mask:0xf bank_mask:0xf
    v_dot2c_f32_bf16_dpp v38, v42, v123 row_newbcast:2 row_mask:0xf bank_mask:0xf
    v_dot2c_f32_bf16_dpp v39, v43, v123 row_newbcast:2 row_mask:0xf bank_mask:0xf
    v_dot2c_f32_bf16_dpp v32, v42, v124 row_newbcast:3 row_mask:0xf bank_mask:0xf
    v_dot2c_f32_bf16_dpp v33, v43, v124 row_newbcast:3 row_mask:0xf bank_mask:0xf
    v_dot2c_f32_bf16_dpp v34, v42, v125 row_newbcast:3 row_mask:0xf bank_mask:0xf
    v_dot2c_f32_bf16_dpp v35, v43, v125 row_newbcast:3 row_mask:0xf bank_mask:0xf
    v_dot2c_f32_bf16_dpp v36, v42, v126 row_newbcast:3 row_mask:0xf bank_mask:0xf
    v_dot2c_f32_bf16_dpp v37, v43, v126 row_newbcast:3 row_mask:0xf bank_mask:0xf
    v_dot2c_f32_bf16_dpp v38, v42, v127 row_newbcast:3 row_mask:0xf bank_mask:0xf
    v_dot2c_f32_bf16_dpp v39, v43, v127 row_newbcast:3 row_mask:0xf bank_mask:0xf
    v_dot2c_f32_bf16_dpp v32, v42, v128 row_newbcast:4 row_mask:0xf bank_mask:0xf
    v_dot2c_f32_bf16_dpp v33, v43, v128 row_newbcast:4 row_mask:0xf bank_mask:0xf
    v_dot2c_f32_bf16_dpp v34, v42, v129 row_newbcast:4 row_mask:0xf bank_mask:0xf
    v_dot2c_f32_bf16_dpp v35, v43, v129 row_newbcast:4 row_mask:0xf bank_mask:0xf
    v_dot2c_f32_bf16_dpp v36, v42, v130 row_newbcast:4 row_mask:0xf bank_mask:0xf
    v_dot2c_f32_bf16_dpp v37, v43, v130 row_newbcast:4 row_mask:0xf bank_mask:0xf
    v_dot2c_f32_bf16_dpp v38, v42, v131 row_newbcast:4 row_mask:0xf bank_mask:0xf
    v_dot2c_f32_bf16_dpp v39, v43, v131 row_newbcast:4 row_mask:0xf bank_mask:0xf
    v_dot2c_f32_bf16_dpp v32, v42, v132 row_newbcast:5 row_mask:0xf bank_mask:0xf
    v_dot2c_f32_bf16_dpp v33, v43, v132 row_newbcast:5 row_mask:0xf bank_mask:0xf
    v_dot2c_f32_bf16_dpp v34, v42, v133 row_newbcast:5 row_mask:0xf bank_mask:0xf
    v_dot2c_f32_bf16_dpp v35, v43, v133 row_newbcast:5 row_mask:0xf bank_mask:0xf
    v_dot2c_f32_bf16_dpp v36, v42, v134 row_newbcast:5 row_mask:0xf bank_mask:0xf
    v_dot2c_f32_bf16_dpp v37, v43, v134 row_newbcast:5 row_mask:0xf bank_mask:0xf
    v_dot2c_f32_bf16_dpp v38, v42, v135 row_newbcast:5 row_mask:0xf bank_mask:0xf
    v_dot2c_f32_bf16_dpp v39, v43, v135 row_newbcast:5 row_mask:0xf bank_mask:0xf
    v_dot2c_f32_bf16_dpp v32, v42, v136 row_newbcast:6 row_mask:0xf bank_mask:0xf
    v_dot2c_f32_bf16_dpp v33, v43, v136 row_newbcast:6 row_mask:0xf bank_mask:0xf
    v_dot2c_f32_bf16_dpp v34, v42, v137 row_newbcast:6 row_mask:0xf bank_mask:0xf
    v_dot2c_f32_bf16_dpp v35, v43, v137 row_newbcast:6 row_mask:0xf bank_mask:0xf
    v_dot2c_f32_bf16_dpp v36, v42, v138 row_newbcast:6 row_mask:0xf bank_mask:0xf
    v_dot2c_f32_bf16_dpp v37, v43, v138 row_newbcast:6 row_mask:0xf bank_mask:0xf
    v_dot2c_f32_bf16_dpp v38, v42, v139 row_newbcast:6 row_mask:0xf bank_mask:0xf
    v_dot2c_f32_bf16_dpp v39, v43, v139 row_newbcast:6 row_mask:0xf bank_mask:0xf
    v_dot2c_f32_bf16_dpp v32, v42, v140 row_newbcast:7 row_mask:0xf bank_mask:0xf
    v_dot2c_f32_bf16_dpp v33, v43, v140 row_newbcast:7 row_mask:0xf bank_mask:0xf
    v_dot2c_f32_bf16_dpp v34, v42, v141 row_newbcast:7 row_mask:0xf bank_mask:0xf
    v_dot2c_f32_bf16_dpp v35, v43, v141 row_newbcast:7 row_mask:0xf bank_mask:0xf
    v_dot2c_f32_bf16_dpp v36, v42, v142 row_newbcast:7 row_mask:0xf bank_mask:0xf
    v_dot2c_f32_bf16_dpp v37, v43, v142 row_newbcast:7 row_mask:0xf bank_mask:0xf
    v_dot2c_f32_bf16_dpp v38, v42, v143 row_newbcast:7 row_mask:0xf bank_mask:0xf
    v_dot2c_f32_bf16_dpp v39, v43, v143 row_newbcast:7 row_mask:0xf bank_mask:0xf
    v_dot2c_f32_bf16_dpp v32, v42, v144 row_newbcast:8 row_mask:0xf bank_mask:0xf
    v_dot2c_f32_bf16_dpp v33, v43, v144 row_newbcast:8 row_mask:0xf bank_mask:0xf
    v_dot2c_f32_bf16_dpp v34, v42, v145 row_newbcast:8 row_mask:0xf bank_mask:0xf
    v_dot2c_f32_bf16_dpp v35, v43, v145 row_newbcast:8 row_mask:0xf bank_mask:0xf
    v_dot2c_f32_bf16_dpp v36, v42, v146 row_newbcast:8 row_mask:0xf bank_mask:0xf
    v_dot2c_f32_bf16_dpp v37, v43, v146 row_newbcast:8 row_mask:0xf bank_mask:0xf
    v_dot2c_f32_bf16_dpp v38, v42, v147 row_newbcast:8 row_mask:0xf bank_mask:0xf
    v_dot2c_f32_bf16_dpp v39, v43, v147 row_newbcast:8 row_mask:0xf bank_mask:0xf
    v_dot2c_f32_bf16_dpp v32, v42, v148 row_newbcast:9 row_mask:0xf bank_mask:0xf
    v_dot2c_f32_bf16_dpp v33, v43, v148 row_newbcast:9 row_mask:0xf bank_mask:0xf
    v_dot2c_f32_bf16_dpp v34, v42, v149 row_newbcast:9 row_mask:0xf bank_mask:0xf
    v_dot2c_f32_bf16_dpp v35, v43, v149 row_newbcast:9 row_mask:0xf bank_mask:0xf
    v_dot2c_f32_bf16_dpp v36, v42, v150 row_newbcast:9 row_mask:0xf bank_mask:0xf
    v_dot2c_f32_bf16_dpp v37, v43, v150 row_newbcast:9 row_mask:0xf bank_mask:0xf
    v_dot2c_f32_bf16_dpp v38, v42, v151 row_newbcast:9 row_mask:0xf bank_mask:0xf
    v_dot2c_f32_bf16_dpp v39, v43, v151 row_newbcast:9 row_mask:0xf bank_mask:0xf
    v_dot2c_f32_bf16_dpp v32, v42, v152 row_newbcast:10 row_mask:0xf bank_mask:0xf
    v_dot2c_f32_bf16_dpp v33, v43, v152 row_newbcast:10 row_mask:0xf bank_mask:0xf
    v_dot2c_f32_bf16_dpp v34, v42, v153 row_newbcast:10 row_mask:0xf bank_mask:0xf
    v_dot2c_f32_bf16_dpp v35, v43, v153 row_newbcast:10 row_mask:0xf bank_mask:0xf
    v_dot2c_f32_bf16_dpp v36, v42, v154 row_newbcast:10 row_mask:0xf bank_mask:0xf
    v_dot2c_f32_bf16_dpp v37, v43, v154 row_newbcast:10 row_mask:0xf bank_mask:0xf
    v_dot2c_f32_bf16_dpp v38, v42, v155 row_newbcast:10 row_mask:0xf bank_mask:0xf
    v_dot2c_f32_bf16_dpp v39, v43, v155 row_newbcast:10 row_mask:0xf bank_mask:0xf
    v_dot2c_f32_bf16_dpp v32, v42, v156 row_newbcast:11 row_mask:0xf bank_mask:0xf
    v_dot2c_f32_bf16_dpp v33, v43, v156 row_newbcast:11 row_mask:0xf bank_mask:0xf
    v_dot2c_f32_bf16_dpp v34, v42, v157 row_newbcast:11 row_mask:0xf bank_mask:0xf
    v_dot2c_f32_bf16_dpp v35, v43, v157 row_newbcast:11 row_mask:0xf bank_mask:0xf
    v_dot2c_f32_bf16_dpp v36, v42, v158 row_newbcast:11 row_mask:0xf bank_mask:0xf
    v_dot2c_f32_bf16_dpp v37, v43, v158 row_newbcast:11 row_mask:0xf bank_mask:0xf
    v_dot2c_f32_bf16_dpp v38, v42, v159 row_newbcast:11 row_mask:0xf bank_mask:0xf
    v_dot2c_f32_bf16_dpp v39, v43, v159 row_newbcast:11 row_mask:0xf bank_mask:0xf
    v_dot2c_f32_bf16_dpp v32, v42, v160 row_newbcast:12 row_mask:0xf bank_mask:0xf
    v_dot2c_f32_bf16_dpp v33, v43, v160 row_newbcast:12 row_mask:0xf bank_mask:0xf
    v_dot2c_f32_bf16_dpp v34, v42, v161 row_newbcast:12 row_mask:0xf bank_mask:0xf
    v_dot2c_f32_bf16_dpp v35, v43, v161 row_newbcast:12 row_mask:0xf bank_mask:0xf
    v_dot2c_f32_bf16_dpp v36, v42, v162 row_newbcast:12 row_mask:0xf bank_mask:0xf
    v_dot2c_f32_bf16_dpp v37, v43, v162 row_newbcast:12 row_mask:0xf bank_mask:0xf
    v_dot2c_f32_bf16_dpp v38, v42, v163 row_newbcast:12 row_mask:0xf bank_mask:0xf
    v_dot2c_f32_bf16_dpp v39, v43, v163 row_newbcast:12 row_mask:0xf bank_mask:0xf
    v_dot2c_f32_bf16_dpp v32, v42, v164 row_newbcast:13 row_mask:0xf bank_mask:0xf
    v_dot2c_f32_bf16_dpp v33, v43, v164 row_newbcast:13 row_mask:0xf bank_mask:0xf
    v_dot2c_f32_bf16_dpp v34, v42, v165 row_newbcast:13 row_mask:0xf bank_mask:0xf
    v_dot2c_f32_bf16_dpp v35, v43, v165 row_newbcast:13 row_mask:0xf bank_mask:0xf
    v_dot2c_f32_bf16_dpp v36, v42, v166 row_newbcast:13 row_mask:0xf bank_mask:0xf
    v_dot2c_f32_bf16_dpp v37, v43, v166 row_newbcast:13 row_mask:0xf bank_mask:0xf
    v_dot2c_f32_bf16_dpp v38, v42, v167 row_newbcast:13 row_mask:0xf bank_mask:0xf
    v_dot2c_f32_bf16_dpp v39, v43, v167 row_newbcast:13 row_mask:0xf bank_mask:0xf
    v_dot2c_f32_bf16_dpp v32, v42, v168 row_newbcast:14 row_mask:0xf bank_mask:0xf
    v_dot2c_f32_bf16_dpp v33, v43, v168 row_newbcast:14 row_mask:0xf bank_mask:0xf
    v_dot2c_f32_bf16_dpp v34, v42, v169 row_newbcast:14 row_mask:0xf bank_mask:0xf
    v_dot2c_f32_bf16_dpp v35, v43, v169 row_newbcast:14 row_mask:0xf bank_mask:0xf
    v_dot2c_f32_bf16_dpp v36, v42, v170 row_newbcast:14 row_mask:0xf bank_mask:0xf
    v_dot2c_f32_bf16_dpp v37, v43, v170 row_newbcast:14 row_mask:0xf bank_mask:0xf
    v_dot2c_f32_bf16_dpp v38, v42, v171 row_newbcast:14 row_mask:0xf bank_mask:0xf
    v_dot2c_f32_bf16_dpp v39, v43, v171 row_newbcast:14 row_mask:0xf bank_mask:0xf
    v_dot2c_f32_bf16_dpp v32, v42, v172 row_newbcast:15 row_mask:0xf bank_mask:0xf
    v_dot2c_f32_bf16_dpp v33, v43, v172 row_newbcast:15 row_mask:0xf bank_mask:0xf
    v_dot2c_f32_bf16_dpp v34, v42, v173 row_newbcast:15 row_mask:0xf bank_mask:0xf
    v_dot2c_f32_bf16_dpp v35, v43, v173 row_newbcast:15 row_mask:0xf bank_mask:0xf
    v_dot2c_f32_bf16_dpp v36, v42, v174 row_newbcast:15 row_mask:0xf bank_mask:0xf
    v_dot2c_f32_bf16_dpp v37, v43, v174 row_newbcast:15 row_mask:0xf bank_mask:0xf
    v_dot2c_f32_bf16_dpp v38, v42, v175 row_newbcast:15 row_mask:0xf bank_mask:0xf
    v_dot2c_f32_bf16_dpp v39, v43, v175 row_newbcast:15 row_mask:0xf bank_mask:0xf
    s_waitcnt vmcnt(4)
    v_dot2c_f32_bf16_dpp v32, v40, v80 row_newbcast:8 row_mask:0xf bank_mask:0xf
    v_dot2c_f32_bf16_dpp v33, v41, v80 row_newbcast:8 row_mask:0xf bank_mask:0xf
    v_dot2c_f32_bf16_dpp v34, v40, v81 row_newbcast:8 row_mask:0xf bank_mask:0xf
    v_dot2c_f32_bf16_dpp v35, v41, v81 row_newbcast:8 row_mask:0xf bank_mask:0xf
    v_dot2c_f32_bf16_dpp v36, v40, v82 row_newbcast:8 row_mask:0xf bank_mask:0xf
    v_dot2c_f32_bf16_dpp v37, v41, v82 row_newbcast:8 row_mask:0xf bank_mask:0xf
    v_dot2c_f32_bf16_dpp v38, v40, v83 row_newbcast:8 row_mask:0xf bank_mask:0xf
    v_dot2c_f32_bf16_dpp v39, v41, v83 row_newbcast:8 row_mask:0xf bank_mask:0xf
    v_dot2c_f32_bf16_dpp v32, v40, v84 row_newbcast:9 row_mask:0xf bank_mask:0xf
    v_dot2c_f32_bf16_dpp v33, v41, v84 row_newbcast:9 row_mask:0xf bank_mask:0xf
    v_dot2c_f32_bf16_dpp v34, v40, v85 row_newbcast:9 row_mask:0xf bank_mask:0xf
    v_dot2c_f32_bf16_dpp v35, v41, v85 row_newbcast:9 row_mask:0xf bank_mask:0xf
    v_dot2c_f32_bf16_dpp v36, v40, v86 row_newbcast:9 row_mask:0xf bank_mask:0xf
    v_dot2c_f32_bf16_dpp v37, v41, v86 row_newbcast:9 row_mask:0xf bank_mask:0xf
    v_dot2c_f32_bf16_dpp v38, v40, v87 row_newbcast:9 row_mask:0xf bank_mask:0xf
    v_dot2c_f32_bf16_dpp v39, v41, v87 row_newbcast:9 row_mask:0xf bank_mask:0xf
    s_waitcnt vmcnt(4)
    s_cmp_eq_u32 s98, -1
    s_cbranch_scc1 L_du_75
    s_and_b32 s6, s98, 127
    s_lshl2_add_u32 s6, s6, 145408
    v_mov_b32 v246, s6
    s_waitcnt lgkmcnt(0)
    v_mov_b32 v247, s99
    ds_write_b32 v246, v247
L_du_75:
    s_cmp_lg_u32 s85, 0
    s_cbranch_scc1 L_vp_70
    s_add_u32 s6, s96, s57
    s_lshr_b32 s7, s6, 2
    s_lshl_b32 s7, s7, 16
    s_and_b32 s13, s6, 3
    s_lshl_b32 s13, s13, 13
    s_or_b32 s13, s13, s7
    s_lshl_b32 s9, s57, 8
    s_add_u32 s9, s9, 99328
    s_cmp_ge_u32 s57, 96
    s_cselect_b32 s13, 0x7f000000, s13
    s_cselect_b32 s9, 144384, s9
    s_mov_b32 s8, 0x7f000000
    s_branch L_ve_71
L_vp_70:
    s_cmp_lg_u32 s85, 1
    s_cbranch_scc1 L_vc_74
    s_cmp_eq_u32 s84, 0
    s_cbranch_scc1 L_vc_74
    s_mov_b32 s84, 0
    s_lshl_b32 s6, s2, 10
    s_add_u32 s6, s6, 0x50040
    s_add_u32 s66, s28, s6
    s_addc_u32 s67, s29, 0
    s_mov_b32 s52, 0
L_sd_76:
    s_load_dword s68, s[66:67], 0x0 glc
    s_load_dword s69, s[66:67], 0x80 glc
    s_load_dword s70, s[66:67], 0x100 glc
    s_load_dword s71, s[66:67], 0x180 glc
    s_load_dword s72, s[66:67], 0x200 glc
    s_load_dword s73, s[66:67], 0x280 glc
    s_load_dword s74, s[66:67], 0x300 glc
    s_load_dword s75, s[66:67], 0x380 glc
    s_add_u32 s52, s52, 1
    s_cmp_gt_u32 s52, 0x80000
    s_cbranch_scc1 L_end
    s_waitcnt lgkmcnt(0)
    s_xor_b32 s6, s68, s11
    s_xor_b32 s7, s69, s11
    s_or_b32 s6, s6, s7
    s_xor_b32 s7, s70, s11
    s_or_b32 s6, s6, s7
    s_xor_b32 s7, s71, s11
    s_or_b32 s6, s6, s7
    s_xor_b32 s7, s72, s11
    s_or_b32 s6, s6, s7
    s_xor_b32 s7, s73, s11
    s_or_b32 s6, s6, s7
    s_xor_b32 s7, s74, s11
    s_or_b32 s6, s6, s7
    s_xor_b32 s7, s75, s11
    s_or_b32 s6, s6, s7
    s_cmp_lg_u32 s6, 0
    s_cbranch_scc1 L_sd_76
L_vc_74:
    s_cmp_eq_u32 s85, 2
    s_cbranch_scc1 L_vn_72
    s_sub_u32 s9, s57, 96
    s_and_b32 s6, s9, 0x1fc
    s_add_u32 s6, s6, 145408
    v_mov_b32 v246, s6
    s_mov_b32 s52, 0
L_rt_77:
    ds_read_b32 v247, v246
    s_add_u32 s52, s52, 1
    s_cmp_gt_u32 s52, 0x800000
    s_cbranch_scc1 L_end
    s_waitcnt lgkmcnt(0)
    v_readfirstlane_b32 s8, v247
    s_nop 0
    s_cmp_eq_u32 s8, -1
    s_cbranch_scc1 L_rt_77
    s_cmp_ge_u32 s8, 64
    s_cbranch_scc1 L_vn_72
    s_and_b32 s9, s9, 3
    s_lshl2_add_u32 s9, s8, s9
    s_mul_i32 s7, s9, 32769
    s_lshr_b32 s7, s7, 20
    s_mul_i32 s7, s7, 96
    s_add_u32 s6, s9, s7
    s_add_u32 s6, s6, 96
    s_lshr_b32 s7, s6, 2
    s_lshl_b32 s7, s7, 16
    s_and_b32 s13, s6, 3
    s_lshl_b32 s13, s13, 13
    s_or_b32 s13, s13, s7
    s_mov_b32 s9, 144384
    s_cmp_lt_u32 s8, 58
    s_cselect_b32 s7, 1, 0
    s_lshl_b32 s8, s6, 7
    s_cmp_lg_u32 s7, 0
    s_cbranch_scc1 L_ve_71
    s_branch L_vf_73
L_vn_72:
    s_mov_b32 s15, 1
    s_mov_b32 s13, 0x7f000000
    s_mov_b32 s8, 0x7f000000
    s_mov_b32 s9, 144384
L_vf_73:
    s_cmp_lg_u32 s62, 0
    s_cbranch_scc1 L_ve_71
    v_mov_b32 v246, 348
    v_mov_b32 v247, 1
    ds_or_b32 v246, v247
L_ve_71:
    buffer_load_ushort v243, v15, s[36:39], s8 offen sc1
    v_add_u32 v242, s9, v240
    ds_read_b32 v242, v242
    buffer_load_dwordx4 v[48:51], v4, s[20:23], s13 offen offset:0 nt
    buffer_load_dwordx4 v[52:55], v6, s[20:23], s13 offen offset:0 nt
    v_dot2c_f32_bf16_dpp v32, v40, v88 row_newbcast:10 row_mask:0xf bank_mask:0xf
    v_dot2c_f32_bf16_dpp v33, v41, v88 row_newbcast:10 row_mask:0xf bank_mask:0xf
    v_dot2c_f32_bf16_dpp v34, v40, v89 row_newbcast:10 row_mask:0xf bank_mask:0xf
    v_dot2c_f32_bf16_dpp v35, v41, v89 row_newbcast:10 row_mask:0xf bank_mask:0xf
    v_dot2c_f32_bf16_dpp v36, v40, v90 row_newbcast:10 row_mask:0xf bank_mask:0xf
    v_dot2c_f32_bf16_dpp v37, v41, v90 row_newbcast:10 row_mask:0xf bank_mask:0xf
    v_dot2c_f32_bf16_dpp v38, v40, v91 row_newbcast:10 row_mask:0xf bank_mask:0xf
    v_dot2c_f32_bf16_dpp v39, v41, v91 row_newbcast:10 row_mask:0xf bank_mask:0xf
    v_dot2c_f32_bf16_dpp v32, v40, v92 row_newbcast:11 row_mask:0xf bank_mask:0xf
    v_dot2c_f32_bf16_dpp v33, v41, v92 row_newbcast:11 row_mask:0xf bank_mask:0xf
    v_dot2c_f32_bf16_dpp v34, v40, v93 row_newbcast:11 row_mask:0xf bank_mask:0xf
    v_dot2c_f32_bf16_dpp v35, v41, v93 row_newbcast:11 row_mask:0xf bank_mask:0xf
    v_dot2c_f32_bf16_dpp v36, v40, v94 row_newbcast:11 row_mask:0xf bank_mask:0xf
    v_dot2c_f32_bf16_dpp v37, v41, v94 row_newbcast:11 row_mask:0xf bank_mask:0xf
    v_dot2c_f32_bf16_dpp v38, v40, v95 row_newbcast:11 row_mask:0xf bank_mask:0xf
    v_dot2c_f32_bf16_dpp v39, v41, v95 row_newbcast:11 row_mask:0xf bank_mask:0xf
    s_waitcnt vmcnt(5)
    buffer_load_dwordx4 v[56:59], v4, s[20:23], s13 offen offset:1024 nt
    buffer_load_dwordx4 v[60:63], v6, s[20:23], s13 offen offset:1024 nt
    v_dot2c_f32_bf16_dpp v32, v40, v96 row_newbcast:12 row_mask:0xf bank_mask:0xf
    v_dot2c_f32_bf16_dpp v33, v41, v96 row_newbcast:12 row_mask:0xf bank_mask:0xf
    v_dot2c_f32_bf16_dpp v34, v40, v97 row_newbcast:12 row_mask:0xf bank_mask:0xf
    v_dot2c_f32_bf16_dpp v35, v41, v97 row_newbcast:12 row_mask:0xf bank_mask:0xf
    v_dot2c_f32_bf16_dpp v36, v40, v98 row_newbcast:12 row_mask:0xf bank_mask:0xf
    v_dot2c_f32_bf16_dpp v37, v41, v98 row_newbcast:12 row_mask:0xf bank_mask:0xf
    v_dot2c_f32_bf16_dpp v38, v40, v99 row_newbcast:12 row_mask:0xf bank_mask:0xf
    v_dot2c_f32_bf16_dpp v39, v41, v99 row_newbcast:12 row_mask:0xf bank_mask:0xf
    v_dot2c_f32_bf16_dpp v32, v40, v100 row_newbcast:13 row_mask:0xf bank_mask:0xf
    v_dot2c_f32_bf16_dpp v33, v41, v100 row_newbcast:13 row_mask:0xf bank_mask:0xf
    v_dot2c_f32_bf16_dpp v34, v40, v101 row_newbcast:13 row_mask:0xf bank_mask:0xf
    v_dot2c_f32_bf16_dpp v35, v41, v101 row_newbcast:13 row_mask:0xf bank_mask:0xf
    v_dot2c_f32_bf16_dpp v36, v40, v102 row_newbcast:13 row_mask:0xf bank_mask:0xf
    v_dot2c_f32_bf16_dpp v37, v41, v102 row_newbcast:13 row_mask:0xf bank_mask:0xf
    v_dot2c_f32_bf16_dpp v38, v40, v103 row_newbcast:13 row_mask:0xf bank_mask:0xf
    v_dot2c_f32_bf16_dpp v39, v41, v103 row_newbcast:13 row_mask:0xf bank_mask:0xf
    s_waitcnt vmcnt(5)
    buffer_load_dwordx4 v[64:67], v4, s[20:23], s13 offen offset:2048 nt
    buffer_load_dwordx4 v[68:71], v6, s[20:23], s13 offen offset:2048 nt
    v_dot2c_f32_bf16_dpp v32, v40, v104 row_newbcast:14 row_mask:0xf bank_mask:0xf
    v_dot2c_f32_bf16_dpp v33, v41, v104 row_newbcast:14 row_mask:0xf bank_mask:0xf
    v_dot2c_f32_bf16_dpp v34, v40, v105 row_newbcast:14 row_mask:0xf bank_mask:0xf
    v_dot2c_f32_bf16_dpp v35, v41, v105 row_newbcast:14 row_mask:0xf bank_mask:0xf
    v_dot2c_f32_bf16_dpp v36, v40, v106 row_newbcast:14 row_mask:0xf bank_mask:0xf
    v_dot2c_f32_bf16_dpp v37, v41, v106 row_newbcast:14 row_mask:0xf bank_mask:0xf
    v_dot2c_f32_bf16_dpp v38, v40, v107 row_newbcast:14 row_mask:0xf bank_mask:0xf
    v_dot2c_f32_bf16_dpp v39, v41, v107 row_newbcast:14 row_mask:0xf bank_mask:0xf
    v_dot2c_f32_bf16_dpp v32, v40, v108 row_newbcast:15 row_mask:0xf bank_mask:0xf
    v_dot2c_f32_bf16_dpp v33, v41, v108 row_newbcast:15 row_mask:0xf bank_mask:0xf
    v_dot2c_f32_bf16_dpp v34, v40, v109 row_newbcast:15 row_mask:0xf bank_mask:0xf
    v_dot2c_f32_bf16_dpp v35, v41, v109 row_newbcast:15 row_mask:0xf bank_mask:0xf
    v_dot2c_f32_bf16_dpp v36, v40, v110 row_newbcast:15 row_mask:0xf bank_mask:0xf
    v_dot2c_f32_bf16_dpp v37, v41, v110 row_newbcast:15 row_mask:0xf bank_mask:0xf
    v_dot2c_f32_bf16_dpp v38, v40, v111 row_newbcast:15 row_mask:0xf bank_mask:0xf
    v_dot2c_f32_bf16_dpp v39, v41, v111 row_newbcast:15 row_mask:0xf bank_mask:0xf
    s_mov_b32 s12, s13
    s_cmp_lg_u32 s15, 0
    s_cbranch_scc1 L_v_lastB
    s_waitcnt vmcnt(4)
    buffer_load_dwordx4 v[72:75], v4, s[20:23], s12 offen offset:3072 nt
    buffer_load_dwordx4 v[76:79], v6, s[20:23], s12 offen offset:3072 nt
    s_waitcnt lgkmcnt(0)
    v_lshl_or_b32 v40, v243, 16, v242
    v_subrev_f32 v40, s50, v40
    v_mul_f32 v40, s46, v40
    v_exp_f32 v40, v40
    s_nop 0
    v_mul_f32 v40, s51, v40
    v_min_f32 v40, 1.0, v40
    v_cvt_pk_bf16_f32 v40, v40, 0
    v_lshlrev_b32 v41, 16, v40
    s_nop 1
    s_mov_b32 s98, -1
    v_mov_b32 v246, 324
    s_mov_b64 exec, 1
    ds_add_rtn_u32 v247, v246, v241
    s_mov_b64 exec, -1
    s_waitcnt lgkmcnt(0)
    v_readfirstlane_b32 s57, v247
    s_nop 0
    s_cmp_ge_u32 s57, 96
    s_cselect_b32 s85, 1, 0
    s_sub_u32 s6, s57, 93
    s_cbranch_scc1 L_rd_78
    s_and_b32 s7, s6, 3
    s_cbranch_scc1 L_rd_78
    s_lshr_b32 s98, s6, 2
    s_cmp_eq_u32 s98, 0
    s_cbranch_scc1 L_ro_81
    s_and_b32 s6, s6, 0x1fc
    s_add_u32 s6, s6, 145404
    v_mov_b32 v246, s6
    s_mov_b32 s52, 0
L_rw_80:
    ds_read_b32 v247, v246
    s_add_u32 s52, s52, 1
    s_cmp_gt_u32 s52, 0x800000
    s_cbranch_scc1 L_end
    s_waitcnt lgkmcnt(0)
    v_readfirstlane_b32 s7, v247
    s_nop 0
    s_cmp_eq_u32 s7, -1
    s_cbranch_scc1 L_rw_80
L_ro_81:
    s_mov_b32 s99, 1
    s_atomic_add s99, s[40:41], 0x80 glc
L_rd_78:
    v_dot2c_f32_bf16_dpp v32, v40, v48 row_newbcast:0 row_mask:0xf bank_mask:0xf
    v_dot2c_f32_bf16_dpp v33, v41, v48 row_newbcast:0 row_mask:0xf bank_mask:0xf
    v_dot2c_f32_bf16_dpp v34, v40, v49 row_newbcast:0 row_mask:0xf bank_mask:0xf
    v_dot2c_f32_bf16_dpp v35, v41, v49 row_newbcast:0 row_mask:0xf bank_mask:0xf
    v_dot2c_f32_bf16_dpp v36, v40, v50 row_newbcast:0 row_mask:0xf bank_mask:0xf
    v_dot2c_f32_bf16_dpp v37, v41, v50 row_newbcast:0 row_mask:0xf bank_mask:0xf
    v_dot2c_f32_bf16_dpp v38, v40, v51 row_newbcast:0 row_mask:0xf bank_mask:0xf
    v_dot2c_f32_bf16_dpp v39, v41, v51 row_newbcast:0 row_mask:0xf bank_mask:0xf
    v_dot2c_f32_bf16_dpp v32, v40, v52 row_newbcast:1 row_mask:0xf bank_mask:0xf
    v_dot2c_f32_bf16_dpp v33, v41, v52 row_newbcast:1 row_mask:0xf bank_mask:0xf
    v_dot2c_f32_bf16_dpp v34, v40, v53 row_newbcast:1 row_mask:0xf bank_mask:0xf
    v_dot2c_f32_bf16_dpp v35, v41, v53 row_newbcast:1 row_mask:0xf bank_mask:0xf
    v_dot2c_f32_bf16_dpp v36, v40, v54 row_newbcast:1 row_mask:0xf bank_mask:0xf
    v_dot2c_f32_bf16_dpp v37, v41, v54 row_newbcast:1 row_mask:0xf bank_mask:0xf
    v_dot2c_f32_bf16_dpp v38, v40, v55 row_newbcast:1 row_mask:0xf bank_mask:0xf
    v_dot2c_f32_bf16_dpp v39, v41, v55 row_newbcast:1 row_mask:0xf bank_mask:0xf
    s_waitcnt vmcnt(4)
    buffer_load_dwordx4 v[80:83], v5, s[20:23], s12 offen offset:0 nt
    buffer_load_dwordx4 v[84:87], v7, s[20:23], s12 offen offset:0 nt
    v_dot2c_f32_bf16_dpp v32, v40, v56 row_newbcast:2 row_mask:0xf bank_mask:0xf
    v_dot2c_f32_bf16_dpp v33, v41, v56 row_newbcast:2 row_mask:0xf bank_mask:0xf
    v_dot2c_f32_bf16_dpp v34, v40, v57 row_newbcast:2 row_mask:0xf bank_mask:0xf
    v_dot2c_f32_bf16_dpp v35, v41, v57 row_newbcast:2 row_mask:0xf bank_mask:0xf
    v_dot2c_f32_bf16_dpp v36, v40, v58 row_newbcast:2 row_mask:0xf bank_mask:0xf
    v_dot2c_f32_bf16_dpp v37, v41, v58 row_newbcast:2 row_mask:0xf bank_mask:0xf
    v_dot2c_f32_bf16_dpp v38, v40, v59 row_newbcast:2 row_mask:0xf bank_mask:0xf
    v_dot2c_f32_bf16_dpp v39, v41, v59 row_newbcast:2 row_mask:0xf bank_mask:0xf
    v_dot2c_f32_bf16_dpp v32, v40, v60 row_newbcast:3 row_mask:0xf bank_mask:0xf
    v_dot2c_f32_bf16_dpp v33, v41, v60 row_newbcast:3 row_mask:0xf bank_mask:0xf
    v_dot2c_f32_bf16_dpp v34, v40, v61 row_newbcast:3 row_mask:0xf bank_mask:0xf
    v_dot2c_f32_bf16_dpp v35, v41, v61 row_newbcast:3 row_mask:0xf bank_mask:0xf
    v_dot2c_f32_bf16_dpp v36, v40, v62 row_newbcast:3 row_mask:0xf bank_mask:0xf
    v_dot2c_f32_bf16_dpp v37, v41, v62 row_newbcast:3 row_mask:0xf bank_mask:0xf
    v_dot2c_f32_bf16_dpp v38, v40, v63 row_newbcast:3 row_mask:0xf bank_mask:0xf
    v_dot2c_f32_bf16_dpp v39, v41, v63 row_newbcast:3 row_mask:0xf bank_mask:0xf
    s_waitcnt vmcnt(4)
    buffer_load_dwordx4 v[88:91], v5, s[20:23], s12 offen offset:1024 nt
    buffer_load_dwordx4 v[92:95], v7, s[20:23], s12 offen offset:1024 nt
    v_dot2c_f32_bf16_dpp v32, v40, v64 row_newbcast:4 row_mask:0xf bank_mask:0xf
    v_dot2c_f32_bf16_dpp v33, v41, v64 row_newbcast:4 row_mask:0xf bank_mask:0xf
    v_dot2c_f32_bf16_dpp v34, v40, v65 row_newbcast:4 row_mask:0xf bank_mask:0xf
    v_dot2c_f32_bf16_dpp v35, v41, v65 row_newbcast:4 row_mask:0xf bank_mask:0xf
    v_dot2c_f32_bf16_dpp v36, v40, v66 row_newbcast:4 row_mask:0xf bank_mask:0xf
    v_dot2c_f32_bf16_dpp v37, v41, v66 row_newbcast:4 row_mask:0xf bank_mask:0xf
    v_dot2c_f32_bf16_dpp v38, v40, v67 row_newbcast:4 row_mask:0xf bank_mask:0xf
    v_dot2c_f32_bf16_dpp v39, v41, v67 row_newbcast:4 row_mask:0xf bank_mask:0xf
    v_dot2c_f32_bf16_dpp v32, v40, v68 row_newbcast:5 row_mask:0xf bank_mask:0xf
    v_dot2c_f32_bf16_dpp v33, v41, v68 row_newbcast:5 row_mask:0xf bank_mask:0xf
    v_dot2c_f32_bf16_dpp v34, v40, v69 row_newbcast:5 row_mask:0xf bank_mask:0xf
    v_dot2c_f32_bf16_dpp v35, v41, v69 row_newbcast:5 row_mask:0xf bank_mask:0xf
    v_dot2c_f32_bf16_dpp v36, v40, v70 row_newbcast:5 row_mask:0xf bank_mask:0xf
    v_dot2c_f32_bf16_dpp v37, v41, v70 row_newbcast:5 row_mask:0xf bank_mask:0xf
    v_dot2c_f32_bf16_dpp v38, v40, v71 row_newbcast:5 row_mask:0xf bank_mask:0xf
    v_dot2c_f32_bf16_dpp v39, v41, v71 row_newbcast:5 row_mask:0xf bank_mask:0xf
    s_waitcnt vmcnt(4)
    buffer_load_dwordx4 v[96:99], v5, s[20:23], s12 offen offset:2048 nt
    buffer_load_dwordx4 v[100:103], v7, s[20:23], s12 offen offset:2048 nt
    v_dot2c_f32_bf16_dpp v32, v40, v72 row_newbcast:6 row_mask:0xf bank_mask:0xf
    v_dot2c_f32_bf16_dpp v33, v41, v72 row_newbcast:6 row_mask:0xf bank_mask:0xf
    v_dot2c_f32_bf16_dpp v34, v40, v73 row_newbcast:6 row_mask:0xf bank_mask:0xf
    v_dot2c_f32_bf16_dpp v35, v41, v73 row_newbcast:6 row_mask:0xf bank_mask:0xf
    v_dot2c_f32_bf16_dpp v36, v40, v74 row_newbcast:6 row_mask:0xf bank_mask:0xf
    v_dot2c_f32_bf16_dpp v37, v41, v74 row_newbcast:6 row_mask:0xf bank_mask:0xf
    v_dot2c_f32_bf16_dpp v38, v40, v75 row_newbcast:6 row_mask:0xf bank_mask:0xf
    v_dot2c_f32_bf16_dpp v39, v41, v75 row_newbcast:6 row_mask:0xf bank_mask:0xf
    v_dot2c_f32_bf16_dpp v32, v40, v76 row_newbcast:7 row_mask:0xf bank_mask:0xf
    v_dot2c_f32_bf16_dpp v33, v41, v76 row_newbcast:7 row_mask:0xf bank_mask:0xf
    v_dot2c_f32_bf16_dpp v34, v40, v77 row_newbcast:7 row_mask:0xf bank_mask:0xf
    v_dot2c_f32_bf16_dpp v35, v41, v77 row_newbcast:7 row_mask:0xf bank_mask:0xf
    v_dot2c_f32_bf16_dpp v36, v40, v78 row_newbcast:7 row_mask:0xf bank_mask:0xf
    v_dot2c_f32_bf16_dpp v37, v41, v78 row_newbcast:7 row_mask:0xf bank_mask:0xf
    v_dot2c_f32_bf16_dpp v38, v40, v79 row_newbcast:7 row_mask:0xf bank_mask:0xf
    v_dot2c_f32_bf16_dpp v39, v41, v79 row_newbcast:7 row_mask:0xf bank_mask:0xf
    v_add_u32 v42, s89, v240
    ds_read_b32 v42, v42
    s_waitcnt lgkmcnt(0)
    v_subrev_f32 v42, s50, v42
    v_mul_f32 v42, s46, v42
    v_exp_f32 v42, v42
    s_nop 0
    v_mul_f32 v42, s51, v42
    v_min_f32 v42, 1.0, v42
    v_cvt_pk_bf16_f32 v42, v42, 0
    v_lshlrev_b32 v43, 16, v42
    s_nop 1
    v_dot2c_f32_bf16_dpp v32, v42, v176 row_newbcast:0 row_mask:0xf bank_mask:0xf
    v_dot2c_f32_bf16_dpp v33, v43, v176 row_newbcast:0 row_mask:0xf bank_mask:0xf
    v_dot2c_f32_bf16_dpp v34, v42, v177 row_newbcast:0 row_mask:0xf bank_mask:0xf
    v_dot2c_f32_bf16_dpp v35, v43, v177 row_newbcast:0 row_mask:0xf bank_mask:0xf
    v_dot2c_f32_bf16_dpp v36, v42, v178 row_newbcast:0 row_mask:0xf bank_mask:0xf
    v_dot2c_f32_bf16_dpp v37, v43, v178 row_newbcast:0 row_mask:0xf bank_mask:0xf
    v_dot2c_f32_bf16_dpp v38, v42, v179 row_newbcast:0 row_mask:0xf bank_mask:0xf
    v_dot2c_f32_bf16_dpp v39, v43, v179 row_newbcast:0 row_mask:0xf bank_mask:0xf
    v_dot2c_f32_bf16_dpp v32, v42, v180 row_newbcast:1 row_mask:0xf bank_mask:0xf
    v_dot2c_f32_bf16_dpp v33, v43, v180 row_newbcast:1 row_mask:0xf bank_mask:0xf
    v_dot2c_f32_bf16_dpp v34, v42, v181 row_newbcast:1 row_mask:0xf bank_mask:0xf
    v_dot2c_f32_bf16_dpp v35, v43, v181 row_newbcast:1 row_mask:0xf bank_mask:0xf
    v_dot2c_f32_bf16_dpp v36, v42, v182 row_newbcast:1 row_mask:0xf bank_mask:0xf
    v_dot2c_f32_bf16_dpp v37, v43, v182 row_newbcast:1 row_mask:0xf bank_mask:0xf
    v_dot2c_f32_bf16_dpp v38, v42, v183 row_newbcast:1 row_mask:0xf bank_mask:0xf
    v_dot2c_f32_bf16_dpp v39, v43, v183 row_newbcast:1 row_mask:0xf bank_mask:0xf
    v_dot2c_f32_bf16_dpp v32, v42, v184 row_newbcast:2 row_mask:0xf bank_mask:0xf
    v_dot2c_f32_bf16_dpp v33, v43, v184 row_newbcast:2 row_mask:0xf bank_mask:0xf
    v_dot2c_f32_bf16_dpp v34, v42, v185 row_newbcast:2 row_mask:0xf bank_mask:0xf
    v_dot2c_f32_bf16_dpp v35, v43, v185 row_newbcast:2 row_mask:0xf bank_mask:0xf
    v_dot2c_f32_bf16_dpp v36, v42, v186 row_newbcast:2 row_mask:0xf bank_mask:0xf
    v_dot2c_f32_bf16_dpp v37, v43, v186 row_newbcast:2 row_mask:0xf bank_mask:0xf
    v_dot2c_f32_bf16_dpp v38, v42, v187 row_newbcast:2 row_mask:0xf bank_mask:0xf
    v_dot2c_f32_bf16_dpp v39, v43, v187 row_newbcast:2 row_mask:0xf bank_mask:0xf
    v_dot2c_f32_bf16_dpp v32, v42, v188 row_newbcast:3 row_mask:0xf bank_mask:0xf
    v_dot2c_f32_bf16_dpp v33, v43, v188 row_newbcast:3 row_mask:0xf bank_mask:0xf
    v_dot2c_f32_bf16_dpp v34, v42, v189 row_newbcast:3 row_mask:0xf bank_mask:0xf
    v_dot2c_f32_bf16_dpp v35, v43, v189 row_newbcast:3 row_mask:0xf bank_mask:0xf
    v_dot2c_f32_bf16_dpp v36, v42, v190 row_newbcast:3 row_mask:0xf bank_mask:0xf
    v_dot2c_f32_bf16_dpp v37, v43, v190 row_newbcast:3 row_mask:0xf bank_mask:0xf
    v_dot2c_f32_bf16_dpp v38, v42, v191 row_newbcast:3 row_mask:0xf bank_mask:0xf
    v_dot2c_f32_bf16_dpp v39, v43, v191 row_newbcast:3 row_mask:0xf bank_mask:0xf
    v_dot2c_f32_bf16_dpp v32, v42, v192 row_newbcast:4 row_mask:0xf bank_mask:0xf
    v_dot2c_f32_bf16_dpp v33, v43, v192 row_newbcast:4 row_mask:0xf bank_mask:0xf
    v_dot2c_f32_bf16_dpp v34, v42, v193 row_newbcast:4 row_mask:0xf bank_mask:0xf
    v_dot2c_f32_bf16_dpp v35, v43, v193 row_newbcast:4 row_mask:0xf bank_mask:0xf
    v_dot2c_f32_bf16_dpp v36, v42, v194 row_newbcast:4 row_mask:0xf bank_mask:0xf
    v_dot2c_f32_bf16_dpp v37, v43, v194 row_newbcast:4 row_mask:0xf bank_mask:0xf
    v_dot2c_f32_bf16_dpp v38, v42, v195 row_newbcast:4 row_mask:0xf bank_mask:0xf
    v_dot2c_f32_bf16_dpp v39, v43, v195 row_newbcast:4 row_mask:0xf bank_mask:0xf
    v_dot2c_f32_bf16_dpp v32, v42, v196 row_newbcast:5 row_mask:0xf bank_mask:0xf
    v_dot2c_f32_bf16_dpp v33, v43, v196 row_newbcast:5 row_mask:0xf bank_mask:0xf
    v_dot2c_f32_bf16_dpp v34, v42, v197 row_newbcast:5 row_mask:0xf bank_mask:0xf
    v_dot2c_f32_bf16_dpp v35, v43, v197 row_newbcast:5 row_mask:0xf bank_mask:0xf
    v_dot2c_f32_bf16_dpp v36, v42, v198 row_newbcast:5 row_mask:0xf bank_mask:0xf
    v_dot2c_f32_bf16_dpp v37, v43, v198 row_newbcast:5 row_mask:0xf bank_mask:0xf
    v_dot2c_f32_bf16_dpp v38, v42, v199 row_newbcast:5 row_mask:0xf bank_mask:0xf
    v_dot2c_f32_bf16_dpp v39, v43, v199 row_newbcast:5 row_mask:0xf bank_mask:0xf
    v_dot2c_f32_bf16_dpp v32, v42, v200 row_newbcast:6 row_mask:0xf bank_mask:0xf
    v_dot2c_f32_bf16_dpp v33, v43, v200 row_newbcast:6 row_mask:0xf bank_mask:0xf
    v_dot2c_f32_bf16_dpp v34, v42, v201 row_newbcast:6 row_mask:0xf bank_mask:0xf
    v_dot2c_f32_bf16_dpp v35, v43, v201 row_newbcast:6 row_mask:0xf bank_mask:0xf
    v_dot2c_f32_bf16_dpp v36, v42, v202 row_newbcast:6 row_mask:0xf bank_mask:0xf
    v_dot2c_f32_bf16_dpp v37, v43, v202 row_newbcast:6 row_mask:0xf bank_mask:0xf
    v_dot2c_f32_bf16_dpp v38, v42, v203 row_newbcast:6 row_mask:0xf bank_mask:0xf
    v_dot2c_f32_bf16_dpp v39, v43, v203 row_newbcast:6 row_mask:0xf bank_mask:0xf
    v_dot2c_f32_bf16_dpp v32, v42, v204 row_newbcast:7 row_mask:0xf bank_mask:0xf
    v_dot2c_f32_bf16_dpp v33, v43, v204 row_newbcast:7 row_mask:0xf bank_mask:0xf
    v_dot2c_f32_bf16_dpp v34, v42, v205 row_newbcast:7 row_mask:0xf bank_mask:0xf
    v_dot2c_f32_bf16_dpp v35, v43, v205 row_newbcast:7 row_mask:0xf bank_mask:0xf
    v_dot2c_f32_bf16_dpp v36, v42, v206 row_newbcast:7 row_mask:0xf bank_mask:0xf
    v_dot2c_f32_bf16_dpp v37, v43, v206 row_newbcast:7 row_mask:0xf bank_mask:0xf
    v_dot2c_f32_bf16_dpp v38, v42, v207 row_newbcast:7 row_mask:0xf bank_mask:0xf
    v_dot2c_f32_bf16_dpp v39, v43, v207 row_newbcast:7 row_mask:0xf bank_mask:0xf
    v_dot2c_f32_bf16_dpp v32, v42, v208 row_newbcast:8 row_mask:0xf bank_mask:0xf
    v_dot2c_f32_bf16_dpp v33, v43, v208 row_newbcast:8 row_mask:0xf bank_mask:0xf
    v_dot2c_f32_bf16_dpp v34, v42, v209 row_newbcast:8 row_mask:0xf bank_mask:0xf
    v_dot2c_f32_bf16_dpp v35, v43, v209 row_newbcast:8 row_mask:0xf bank_mask:0xf
    v_dot2c_f32_bf16_dpp v36, v42, v210 row_newbcast:8 row_mask:0xf bank_mask:0xf
    v_dot2c_f32_bf16_dpp v37, v43, v210 row_newbcast:8 row_mask:0xf bank_mask:0xf
    v_dot2c_f32_bf16_dpp v38, v42, v211 row_newbcast:8 row_mask:0xf bank_mask:0xf
    v_dot2c_f32_bf16_dpp v39, v43, v211 row_newbcast:8 row_mask:0xf bank_mask:0xf
    v_dot2c_f32_bf16_dpp v32, v42, v212 row_newbcast:9 row_mask:0xf bank_mask:0xf
    v_dot2c_f32_bf16_dpp v33, v43, v212 row_newbcast:9 row_mask:0xf bank_mask:0xf
    v_dot2c_f32_bf16_dpp v34, v42, v213 row_newbcast:9 row_mask:0xf bank_mask:0xf
    v_dot2c_f32_bf16_dpp v35, v43, v213 row_newbcast:9 row_mask:0xf bank_mask:0xf
    v_dot2c_f32_bf16_dpp v36, v42, v214 row_newbcast:9 row_mask:0xf bank_mask:0xf
    v_dot2c_f32_bf16_dpp v37, v43, v214 row_newbcast:9 row_mask:0xf bank_mask:0xf
    v_dot2c_f32_bf16_dpp v38, v42, v215 row_newbcast:9 row_mask:0xf bank_mask:0xf
    v_dot2c_f32_bf16_dpp v39, v43, v215 row_newbcast:9 row_mask:0xf bank_mask:0xf
    v_dot2c_f32_bf16_dpp v32, v42, v216 row_newbcast:10 row_mask:0xf bank_mask:0xf
    v_dot2c_f32_bf16_dpp v33, v43, v216 row_newbcast:10 row_mask:0xf bank_mask:0xf
    v_dot2c_f32_bf16_dpp v34, v42, v217 row_newbcast:10 row_mask:0xf bank_mask:0xf
    v_dot2c_f32_bf16_dpp v35, v43, v217 row_newbcast:10 row_mask:0xf bank_mask:0xf
    v_dot2c_f32_bf16_dpp v36, v42, v218 row_newbcast:10 row_mask:0xf bank_mask:0xf
    v_dot2c_f32_bf16_dpp v37, v43, v218 row_newbcast:10 row_mask:0xf bank_mask:0xf
    v_dot2c_f32_bf16_dpp v38, v42, v219 row_newbcast:10 row_mask:0xf bank_mask:0xf
    v_dot2c_f32_bf16_dpp v39, v43, v219 row_newbcast:10 row_mask:0xf bank_mask:0xf
    v_dot2c_f32_bf16_dpp v32, v42, v220 row_newbcast:11 row_mask:0xf bank_mask:0xf
    v_dot2c_f32_bf16_dpp v33, v43, v220 row_newbcast:11 row_mask:0xf bank_mask:0xf
    v_dot2c_f32_bf16_dpp v34, v42, v221 row_newbcast:11 row_mask:0xf bank_mask:0xf
    v_dot2c_f32_bf16_dpp v35, v43, v221 row_newbcast:11 row_mask:0xf bank_mask:0xf
    v_dot2c_f32_bf16_dpp v36, v42, v222 row_newbcast:11 row_mask:0xf bank_mask:0xf
    v_dot2c_f32_bf16_dpp v37, v43, v222 row_newbcast:11 row_mask:0xf bank_mask:0xf
    v_dot2c_f32_bf16_dpp v38, v42, v223 row_newbcast:11 row_mask:0xf bank_mask:0xf
    v_dot2c_f32_bf16_dpp v39, v43, v223 row_newbcast:11 row_mask:0xf bank_mask:0xf
    v_dot2c_f32_bf16_dpp v32, v42, v224 row_newbcast:12 row_mask:0xf bank_mask:0xf
    v_dot2c_f32_bf16_dpp v33, v43, v224 row_newbcast:12 row_mask:0xf bank_mask:0xf
    v_dot2c_f32_bf16_dpp v34, v42, v225 row_newbcast:12 row_mask:0xf bank_mask:0xf
    v_dot2c_f32_bf16_dpp v35, v43, v225 row_newbcast:12 row_mask:0xf bank_mask:0xf
    v_dot2c_f32_bf16_dpp v36, v42, v226 row_newbcast:12 row_mask:0xf bank_mask:0xf
    v_dot2c_f32_bf16_dpp v37, v43, v226 row_newbcast:12 row_mask:0xf bank_mask:0xf
    v_dot2c_f32_bf16_dpp v38, v42, v227 row_newbcast:12 row_mask:0xf bank_mask:0xf
    v_dot2c_f32_bf16_dpp v39, v43, v227 row_newbcast:12 row_mask:0xf bank_mask:0xf
    v_dot2c_f32_bf16_dpp v32, v42, v228 row_newbcast:13 row_mask:0xf bank_mask:0xf
    v_dot2c_f32_bf16_dpp v33, v43, v228 row_newbcast:13 row_mask:0xf bank_mask:0xf
    v_dot2c_f32_bf16_dpp v34, v42, v229 row_newbcast:13 row_mask:0xf bank_mask:0xf
    v_dot2c_f32_bf16_dpp v35, v43, v229 row_newbcast:13 row_mask:0xf bank_mask:0xf
    v_dot2c_f32_bf16_dpp v36, v42, v230 row_newbcast:13 row_mask:0xf bank_mask:0xf
    v_dot2c_f32_bf16_dpp v37, v43, v230 row_newbcast:13 row_mask:0xf bank_mask:0xf
    v_dot2c_f32_bf16_dpp v38, v42, v231 row_newbcast:13 row_mask:0xf bank_mask:0xf
    v_dot2c_f32_bf16_dpp v39, v43, v231 row_newbcast:13 row_mask:0xf bank_mask:0xf
    v_dot2c_f32_bf16_dpp v32, v42, v232 row_newbcast:14 row_mask:0xf bank_mask:0xf
    v_dot2c_f32_bf16_dpp v33, v43, v232 row_newbcast:14 row_mask:0xf bank_mask:0xf
    v_dot2c_f32_bf16_dpp v34, v42, v233 row_newbcast:14 row_mask:0xf bank_mask:0xf
    v_dot2c_f32_bf16_dpp v35, v43, v233 row_newbcast:14 row_mask:0xf bank_mask:0xf
    v_dot2c_f32_bf16_dpp v36, v42, v234 row_newbcast:14 row_mask:0xf bank_mask:0xf
    v_dot2c_f32_bf16_dpp v37, v43, v234 row_newbcast:14 row_mask:0xf bank_mask:0xf
    v_dot2c_f32_bf16_dpp v38, v42, v235 row_newbcast:14 row_mask:0xf bank_mask:0xf
    v_dot2c_f32_bf16_dpp v39, v43, v235 row_newbcast:14 row_mask:0xf bank_mask:0xf
    v_dot2c_f32_bf16_dpp v32, v42, v236 row_newbcast:15 row_mask:0xf bank_mask:0xf
    v_dot2c_f32_bf16_dpp v33, v43, v236 row_newbcast:15 row_mask:0xf bank_mask:0xf
    v_dot2c_f32_bf16_dpp v34, v42, v237 row_newbcast:15 row_mask:0xf bank_mask:0xf
    v_dot2c_f32_bf16_dpp v35, v43, v237 row_newbcast:15 row_mask:0xf bank_mask:0xf
    v_dot2c_f32_bf16_dpp v36, v42, v238 row_newbcast:15 row_mask:0xf bank_mask:0xf
    v_dot2c_f32_bf16_dpp v37, v43, v238 row_newbcast:15 row_mask:0xf bank_mask:0xf
    v_dot2c_f32_bf16_dpp v38, v42, v239 row_newbcast:15 row_mask:0xf bank_mask:0xf
    v_dot2c_f32_bf16_dpp v39, v43, v239 row_newbcast:15 row_mask:0xf bank_mask:0xf
    s_waitcnt vmcnt(4)
    buffer_load_dwordx4 v[104:107], v5, s[20:23], s12 offen offset:3072 nt
    buffer_load_dwordx4 v[108:111], v7, s[20:23], s12 offen offset:3072 nt
    v_dot2c_f32_bf16_dpp v32, v40, v80 row_newbcast:8 row_mask:0xf bank_mask:0xf
    v_dot2c_f32_bf16_dpp v33, v41, v80 row_newbcast:8 row_mask:0xf bank_mask:0xf
    v_dot2c_f32_bf16_dpp v34, v40, v81 row_newbcast:8 row_mask:0xf bank_mask:0xf
    v_dot2c_f32_bf16_dpp v35, v41, v81 row_newbcast:8 row_mask:0xf bank_mask:0xf
    v_dot2c_f32_bf16_dpp v36, v40, v82 row_newbcast:8 row_mask:0xf bank_mask:0xf
    v_dot2c_f32_bf16_dpp v37, v41, v82 row_newbcast:8 row_mask:0xf bank_mask:0xf
    v_dot2c_f32_bf16_dpp v38, v40, v83 row_newbcast:8 row_mask:0xf bank_mask:0xf
    v_dot2c_f32_bf16_dpp v39, v41, v83 row_newbcast:8 row_mask:0xf bank_mask:0xf
    v_dot2c_f32_bf16_dpp v32, v40, v84 row_newbcast:9 row_mask:0xf bank_mask:0xf
    v_dot2c_f32_bf16_dpp v33, v41, v84 row_newbcast:9 row_mask:0xf bank_mask:0xf
    v_dot2c_f32_bf16_dpp v34, v40, v85 row_newbcast:9 row_mask:0xf bank_mask:0xf
    v_dot2c_f32_bf16_dpp v35, v41, v85 row_newbcast:9 row_mask:0xf bank_mask:0xf
    v_dot2c_f32_bf16_dpp v36, v40, v86 row_newbcast:9 row_mask:0xf bank_mask:0xf
    v_dot2c_f32_bf16_dpp v37, v41, v86 row_newbcast:9 row_mask:0xf bank_mask:0xf
    v_dot2c_f32_bf16_dpp v38, v40, v87 row_newbcast:9 row_mask:0xf bank_mask:0xf
    v_dot2c_f32_bf16_dpp v39, v41, v87 row_newbcast:9 row_mask:0xf bank_mask:0xf
    s_waitcnt vmcnt(4)
    s_cmp_eq_u32 s98, -1
    s_cbranch_scc1 L_du_87
    s_and_b32 s6, s98, 127
    s_lshl2_add_u32 s6, s6, 145408
    v_mov_b32 v246, s6
    s_waitcnt lgkmcnt(0)
    v_mov_b32 v247, s99
    ds_write_b32 v246, v247
L_du_87:
    s_cmp_lg_u32 s85, 0
    s_cbranch_scc1 L_vp_82
    s_add_u32 s6, s96, s57
    s_lshr_b32 s7, s6, 2
    s_lshl_b32 s7, s7, 16
    s_and_b32 s13, s6, 3
    s_lshl_b32 s13, s13, 13
    s_or_b32 s13, s13, s7
    s_lshl_b32 s9, s57, 8
    s_add_u32 s9, s9, 99328
    s_cmp_ge_u32 s57, 96
    s_cselect_b32 s13, 0x7f000000, s13
    s_cselect_b32 s9, 144384, s9
    s_mov_b32 s8, 0x7f000000
    s_branch L_ve_83
L_vp_82:
    s_cmp_lg_u32 s85, 1
    s_cbranch_scc1 L_vc_86
    s_cmp_eq_u32 s84, 0
    s_cbranch_scc1 L_vc_86
    s_mov_b32 s84, 0
    s_lshl_b32 s6, s2, 10
    s_add_u32 s6, s6, 0x50040
    s_add_u32 s66, s28, s6
    s_addc_u32 s67, s29, 0
    s_mov_b32 s52, 0
L_sd_88:
    s_load_dword s68, s[66:67], 0x0 glc
    s_load_dword s69, s[66:67], 0x80 glc
    s_load_dword s70, s[66:67], 0x100 glc
    s_load_dword s71, s[66:67], 0x180 glc
    s_load_dword s72, s[66:67], 0x200 glc
    s_load_dword s73, s[66:67], 0x280 glc
    s_load_dword s74, s[66:67], 0x300 glc
    s_load_dword s75, s[66:67], 0x380 glc
    s_add_u32 s52, s52, 1
    s_cmp_gt_u32 s52, 0x80000
    s_cbranch_scc1 L_end
    s_waitcnt lgkmcnt(0)
    s_xor_b32 s6, s68, s11
    s_xor_b32 s7, s69, s11
    s_or_b32 s6, s6, s7
    s_xor_b32 s7, s70, s11
    s_or_b32 s6, s6, s7
    s_xor_b32 s7, s71, s11
    s_or_b32 s6, s6, s7
    s_xor_b32 s7, s72, s11
    s_or_b32 s6, s6, s7
    s_xor_b32 s7, s73, s11
    s_or_b32 s6, s6, s7
    s_xor_b32 s7, s74, s11
    s_or_b32 s6, s6, s7
    s_xor_b32 s7, s75, s11
    s_or_b32 s6, s6, s7
    s_cmp_lg_u32 s6, 0
    s_cbranch_scc1 L_sd_88
L_vc_86:
    s_cmp_eq_u32 s85, 2
    s_cbranch_scc1 L_vn_84
    s_sub_u32 s9, s57, 96
    s_and_b32 s6, s9, 0x1fc
    s_add_u32 s6, s6, 145408
    v_mov_b32 v246, s6
    s_mov_b32 s52, 0
L_rt_89:
    ds_read_b32 v247, v246
    s_add_u32 s52, s52, 1
    s_cmp_gt_u32 s52, 0x800000
    s_cbranch_scc1 L_end
    s_waitcnt lgkmcnt(0)
    v_readfirstlane_b32 s8, v247
    s_nop 0
    s_cmp_eq_u32 s8, -1
    s_cbranch_scc1 L_rt_89
    s_cmp_ge_u32 s8, 64
    s_cbranch_scc1 L_vn_84
    s_and_b32 s9, s9, 3
    s_lshl2_add_u32 s9, s8, s9
    s_mul_i32 s7, s9, 32769
    s_lshr_b32 s7, s7, 20
    s_mul_i32 s7, s7, 96
    s_add_u32 s6, s9, s7
    s_add_u32 s6, s6, 96
    s_lshr_b32 s7, s6, 2
    s_lshl_b32 s7, s7, 16
    s_and_b32 s13, s6, 3
    s_lshl_b32 s13, s13, 13
    s_or_b32 s13, s13, s7
    s_mov_b32 s9, 144384
    s_cmp_lt_u32 s8, 58
    s_cselect_b32 s7, 1, 0
    s_lshl_b32 s8, s6, 7
    s_cmp_lg_u32 s7, 0
    s_cbranch_scc1 L_ve_83
    s_branch L_vf_85
L_vn_84:
    s_mov_b32 s15, 1
    s_mov_b32 s13, 0x7f000000
    s_mov_b32 s8, 0x7f000000
    s_mov_b32 s9, 144384
L_vf_85:
    s_cmp_lg_u32 s62, 0
    s_cbranch_scc1 L_ve_83
    v_mov_b32 v246, 348
    v_mov_b32 v247, 1
    ds_or_b32 v246, v247
L_ve_83:
    buffer_load_ushort v243, v15, s[36:39], s8 offen sc1
    v_add_u32 v242, s9, v240
    ds_read_b32 v242, v242
    buffer_load_dwordx4 v[48:51], v4, s[20:23], s13 offen offset:0 nt
    buffer_load_dwordx4 v[52:55], v6, s[20:23], s13 offen offset:0 nt
    v_dot2c_f32_bf16_dpp v32, v40, v88 row_newbcast:10 row_mask:0xf bank_mask:0xf
    v_dot2c_f32_bf16_dpp v33, v41, v88 row_newbcast:10 row_mask:0xf bank_mask:0xf
    v_dot2c_f32_bf16_dpp v34, v40, v89 row_newbcast:10 row_mask:0xf bank_mask:0xf
    v_dot2c_f32_bf16_dpp v35, v41, v89 row_newbcast:10 row_mask:0xf bank_mask:0xf
    v_dot2c_f32_bf16_dpp v36, v40, v90 row_newbcast:10 row_mask:0xf bank_mask:0xf
    v_dot2c_f32_bf16_dpp v37, v41, v90 row_newbcast:10 row_mask:0xf bank_mask:0xf
    v_dot2c_f32_bf16_dpp v38, v40, v91 row_newbcast:10 row_mask:0xf bank_mask:0xf
    v_dot2c_f32_bf16_dpp v39, v41, v91 row_newbcast:10 row_mask:0xf bank_mask:0xf
    v_dot2c_f32_bf16_dpp v32, v40, v92 row_newbcast:11 row_mask:0xf bank_mask:0xf
    v_dot2c_f32_bf16_dpp v33, v41, v92 row_newbcast:11 row_mask:0xf bank_mask:0xf
    v_dot2c_f32_bf16_dpp v34, v40, v93 row_newbcast:11 row_mask:0xf bank_mask:0xf
    v_dot2c_f32_bf16_dpp v35, v41, v93 row_newbcast:11 row_mask:0xf bank_mask:0xf
    v_dot2c_f32_bf16_dpp v36, v40, v94 row_newbcast:11 row_mask:0xf bank_mask:0xf
    v_dot2c_f32_bf16_dpp v37, v41, v94 row_newbcast:11 row_mask:0xf bank_mask:0xf
    v_dot2c_f32_bf16_dpp v38, v40, v95 row_newbcast:11 row_mask:0xf bank_mask:0xf
    v_dot2c_f32_bf16_dpp v39, v41, v95 row_newbcast:11 row_mask:0xf bank_mask:0xf
    s_waitcnt vmcnt(5)
    buffer_load_dwordx4 v[56:59], v4, s[20:23], s13 offen offset:1024 nt
    buffer_load_dwordx4 v[60:63], v6, s[20:23], s13 offen offset:1024 nt
    v_dot2c_f32_bf16_dpp v32, v40, v96 row_newbcast:12 row_mask:0xf bank_mask:0xf
    v_dot2c_f32_bf16_dpp v33, v41, v96 row_newbcast:12 row_mask:0xf bank_mask:0xf
    v_dot2c_f32_bf16_dpp v34, v40, v97 row_newbcast:12 row_mask:0xf bank_mask:0xf
    v_dot2c_f32_bf16_dpp v35, v41, v97 row_newbcast:12 row_mask:0xf bank_mask:0xf
    v_dot2c_f32_bf16_dpp v36, v40, v98 row_newbcast:12 row_mask:0xf bank_mask:0xf
    v_dot2c_f32_bf16_dpp v37, v41, v98 row_newbcast:12 row_mask:0xf bank_mask:0xf
    v_dot2c_f32_bf16_dpp v38, v40, v99 row_newbcast:12 row_mask:0xf bank_mask:0xf
    v_dot2c_f32_bf16_dpp v39, v41, v99 row_newbcast:12 row_mask:0xf bank_mask:0xf
    v_dot2c_f32_bf16_dpp v32, v40, v100 row_newbcast:13 row_mask:0xf bank_mask:0xf
    v_dot2c_f32_bf16_dpp v33, v41, v100 row_newbcast:13 row_mask:0xf bank_mask:0xf
    v_dot2c_f32_bf16_dpp v34, v40, v101 row_newbcast:13 row_mask:0xf bank_mask:0xf
    v_dot2c_f32_bf16_dpp v35, v41, v101 row_newbcast:13 row_mask:0xf bank_mask:0xf
    v_dot2c_f32_bf16_dpp v36, v40, v102 row_newbcast:13 row_mask:0xf bank_mask:0xf
    v_dot2c_f32_bf16_dpp v37, v41, v102 row_newbcast:13 row_mask:0xf bank_mask:0xf
    v_dot2c_f32_bf16_dpp v38, v40, v103 row_newbcast:13 row_mask:0xf bank_mask:0xf
    v_dot2c_f32_bf16_dpp v39, v41, v103 row_newbcast:13 row_mask:0xf bank_mask:0xf
    s_waitcnt vmcnt(5)
    buffer_load_dwordx4 v[64:67], v4, s[20:23], s13 offen offset:2048 nt
    buffer_load_dwordx4 v[68:71], v6, s[20:23], s13 offen offset:2048 nt
    v_dot2c_f32_bf16_dpp v32, v40, v104 row_newbcast:14 row_mask:0xf bank_mask:0xf
    v_dot2c_f32_bf16_dpp v33, v41, v104 row_newbcast:14 row_mask:0xf bank_mask:0xf
    v_dot2c_f32_bf16_dpp v34, v40, v105 row_newbcast:14 row_mask:0xf bank_mask:0xf
    v_dot2c_f32_bf16_dpp v35, v41, v105 row_newbcast:14 row_mask:0xf bank_mask:0xf
    v_dot2c_f32_bf16_dpp v36, v40, v106 row_newbcast:14 row_mask:0xf bank_mask:0xf
    v_dot2c_f32_bf16_dpp v37, v41, v106 row_newbcast:14 row_mask:0xf bank_mask:0xf
    v_dot2c_f32_bf16_dpp v38, v40, v107 row_newbcast:14 row_mask:0xf bank_mask:0xf
    v_dot2c_f32_bf16_dpp v39, v41, v107 row_newbcast:14 row_mask:0xf bank_mask:0xf
    v_dot2c_f32_bf16_dpp v32, v40, v108 row_newbcast:15 row_mask:0xf bank_mask:0xf
    v_dot2c_f32_bf16_dpp v33, v41, v108 row_newbcast:15 row_mask:0xf bank_mask:0xf
    v_dot2c_f32_bf16_dpp v34, v40, v109 row_newbcast:15 row_mask:0xf bank_mask:0xf
    v_dot2c_f32_bf16_dpp v35, v41, v109 row_newbcast:15 row_mask:0xf bank_mask:0xf
    v_dot2c_f32_bf16_dpp v36, v40, v110 row_newbcast:15 row_mask:0xf bank_mask:0xf
    v_dot2c_f32_bf16_dpp v37, v41, v110 row_newbcast:15 row_mask:0xf bank_mask:0xf
    v_dot2c_f32_bf16_dpp v38, v40, v111 row_newbcast:15 row_mask:0xf bank_mask:0xf
    v_dot2c_f32_bf16_dpp v39, v41, v111 row_newbcast:15 row_mask:0xf bank_mask:0xf
    s_mov_b32 s12, s13
    s_cmp_lg_u32 s15, 0
    s_cbranch_scc1 L_vdone
L_vloop:
    s_waitcnt vmcnt(4)
    buffer_load_dwordx4 v[72:75], v4, s[20:23], s12 offen offset:3072 nt
    buffer_load_dwordx4 v[76:79], v6, s[20:23], s12 offen offset:3072 nt
    s_waitcnt lgkmcnt(0)
    v_lshl_or_b32 v40, v243, 16, v242
    v_subrev_f32 v40, s50, v40
    v_mul_f32 v40, s46, v40
    v_exp_f32 v40, v40
    s_nop 0
    v_mul_f32 v40, s51, v40
    v_min_f32 v40, 1.0, v40
    v_cvt_pk_bf16_f32 v40, v40, 0
    v_lshlrev_b32 v41, 16, v40
    s_nop 1
    s_mov_b32 s98, -1
    v_mov_b32 v246, 324
    s_mov_b64 exec, 1
    ds_add_rtn_u32 v247, v246, v241
    s_mov_b64 exec, -1
    s_waitcnt lgkmcnt(0)
    v_readfirstlane_b32 s57, v247
    s_nop 0
    s_cmp_ge_u32 s57, 96
    s_cselect_b32 s85, 1, 0
    s_sub_u32 s6, s57, 93
    s_cbranch_scc1 L_rd_90
    s_and_b32 s7, s6, 3
    s_cbranch_scc1 L_rd_90
    s_lshr_b32 s98, s6, 2
    s_cmp_eq_u32 s98, 0
    s_cbranch_scc1 L_ro_93
    s_and_b32 s6, s6, 0x1fc
    s_add_u32 s6, s6, 145404
    v_mov_b32 v246, s6
    s_mov_b32 s52, 0
L_rw_92:
    ds_read_b32 v247, v246
    s_add_u32 s52, s52, 1
    s_cmp_gt_u32 s52, 0x800000
    s_cbranch_scc1 L_end
    s_waitcnt lgkmcnt(0)
    v_readfirstlane_b32 s7, v247
    s_nop 0
    s_cmp_eq_u32 s7, -1
    s_cbranch_scc1 L_rw_92
L_ro_93:
    s_mov_b32 s99, 1
    s_atomic_add s99, s[40:41], 0x80 glc
L_rd_90:
    v_dot2c_f32_bf16_dpp v32, v40, v48 row_newbcast:0 row_mask:0xf bank_mask:0xf
    v_dot2c_f32_bf16_dpp v33, v41, v48 row_newbcast:0 row_mask:0xf bank_mask:0xf
    v_dot2c_f32_bf16_dpp v34, v40, v49 row_newbcast:0 row_mask:0xf bank_mask:0xf
    v_dot2c_f32_bf16_dpp v35, v41, v49 row_newbcast:0 row_mask:0xf bank_mask:0xf
    v_dot2c_f32_bf16_dpp v36, v40, v50 row_newbcast:0 row_mask:0xf bank_mask:0xf
    v_dot2c_f32_bf16_dpp v37, v41, v50 row_newbcast:0 row_mask:0xf bank_mask:0xf
    v_dot2c_f32_bf16_dpp v38, v40, v51 row_newbcast:0 row_mask:0xf bank_mask:0xf
    v_dot2c_f32_bf16_dpp v39, v41, v51 row_newbcast:0 row_mask:0xf bank_mask:0xf
    v_dot2c_f32_bf16_dpp v32, v40, v52 row_newbcast:1 row_mask:0xf bank_mask:0xf
    v_dot2c_f32_bf16_dpp v33, v41, v52 row_newbcast:1 row_mask:0xf bank_mask:0xf
    v_dot2c_f32_bf16_dpp v34, v40, v53 row_newbcast:1 row_mask:0xf bank_mask:0xf
    v_dot2c_f32_bf16_dpp v35, v41, v53 row_newbcast:1 row_mask:0xf bank_mask:0xf
    v_dot2c_f32_bf16_dpp v36, v40, v54 row_newbcast:1 row_mask:0xf bank_mask:0xf
    v_dot2c_f32_bf16_dpp v37, v41, v54 row_newbcast:1 row_mask:0xf bank_mask:0xf
    v_dot2c_f32_bf16_dpp v38, v40, v55 row_newbcast:1 row_mask:0xf bank_mask:0xf
    v_dot2c_f32_bf16_dpp v39, v41, v55 row_newbcast:1 row_mask:0xf bank_mask:0xf
    s_waitcnt vmcnt(4)
    buffer_load_dwordx4 v[80:83], v5, s[20:23], s12 offen offset:0 nt
    buffer_load_dwordx4 v[84:87], v7, s[20:23], s12 offen offset:0 nt
    v_dot2c_f32_bf16_dpp v32, v40, v56 row_newbcast:2 row_mask:0xf bank_mask:0xf
    v_dot2c_f32_bf16_dpp v33, v41, v56 row_newbcast:2 row_mask:0xf bank_mask:0xf
    v_dot2c_f32_bf16_dpp v34, v40, v57 row_newbcast:2 row_mask:0xf bank_mask:0xf
    v_dot2c_f32_bf16_dpp v35, v41, v57 row_newbcast:2 row_mask:0xf bank_mask:0xf
    v_dot2c_f32_bf16_dpp v36, v40, v58 row_newbcast:2 row_mask:0xf bank_mask:0xf
    v_dot2c_f32_bf16_dpp v37, v41, v58 row_newbcast:2 row_mask:0xf bank_mask:0xf
    v_dot2c_f32_bf16_dpp v38, v40, v59 row_newbcast:2 row_mask:0xf bank_mask:0xf
    v_dot2c_f32_bf16_dpp v39, v41, v59 row_newbcast:2 row_mask:0xf bank_mask:0xf
    v_dot2c_f32_bf16_dpp v32, v40, v60 row_newbcast:3 row_mask:0xf bank_mask:0xf
    v_dot2c_f32_bf16_dpp v33, v41, v60 row_newbcast:3 row_mask:0xf bank_mask:0xf
    v_dot2c_f32_bf16_dpp v34, v40, v61 row_newbcast:3 row_mask:0xf bank_mask:0xf
    v_dot2c_f32_bf16_dpp v35, v41, v61 row_newbcast:3 row_mask:0xf bank_mask:0xf
    v_dot2c_f32_bf16_dpp v36, v40, v62 row_newbcast:3 row_mask:0xf bank_mask:0xf
    v_dot2c_f32_bf16_dpp v37, v41, v62 row_newbcast:3 row_mask:0xf bank_mask:0xf
    v_dot2c_f32_bf16_dpp v38, v40, v63 row_newbcast:3 row_mask:0xf bank_mask:0xf
    v_dot2c_f32_bf16_dpp v39, v41, v63 row_newbcast:3 row_mask:0xf bank_mask:0xf
    s_waitcnt vmcnt(4)
    buffer_load_dwordx4 v[88:91], v5, s[20:23], s12 offen offset:1024 nt
    buffer_load_dwordx4 v[92:95], v7, s[20:23], s12 offen offset:1024 nt
    v_dot2c_f32_bf16_dpp v32, v40, v64 row_newbcast:4 row_mask:0xf bank_mask:0xf
    v_dot2c_f32_bf16_dpp v33, v41, v64 row_newbcast:4 row_mask:0xf bank_mask:0xf
    v_dot2c_f32_bf16_dpp v34, v40, v65 row_newbcast:4 row_mask:0xf bank_mask:0xf
    v_dot2c_f32_bf16_dpp v35, v41, v65 row_newbcast:4 row_mask:0xf bank_mask:0xf
    v_dot2c_f32_bf16_dpp v36, v40, v66 row_newbcast:4 row_mask:0xf bank_mask:0xf
    v_dot2c_f32_bf16_dpp v37, v41, v66 row_newbcast:4 row_mask:0xf bank_mask:0xf
    v_dot2c_f32_bf16_dpp v38, v40, v67 row_newbcast:4 row_mask:0xf bank_mask:0xf
    v_dot2c_f32_bf16_dpp v39, v41, v67 row_newbcast:4 row_mask:0xf bank_mask:0xf
    v_dot2c_f32_bf16_dpp v32, v40, v68 row_newbcast:5 row_mask:0xf bank_mask:0xf
    v_dot2c_f32_bf16_dpp v33, v41, v68 row_newbcast:5 row_mask:0xf bank_mask:0xf
    v_dot2c_f32_bf16_dpp v34, v40, v69 row_newbcast:5 row_mask:0xf bank_mask:0xf
    v_dot2c_f32_bf16_dpp v35, v41, v69 row_newbcast:5 row_mask:0xf bank_mask:0xf
    v_dot2c_f32_bf16_dpp v36, v40, v70 row_newbcast:5 row_mask:0xf bank_mask:0xf
    v_dot2c_f32_bf16_dpp v37, v41, v70 row_newbcast:5 row_mask:0xf bank_mask:0xf
    v_dot2c_f32_bf16_dpp v38, v40, v71 row_newbcast:5 row_mask:0xf bank_mask:0xf
    v_dot2c_f32_bf16_dpp v39, v41, v71 row_newbcast:5 row_mask:0xf bank_mask:0xf
    s_waitcnt vmcnt(4)
    buffer_load_dwordx4 v[96:99], v5, s[20:23], s12 offen offset:2048 nt
    buffer_load_dwordx4 v[100:103], v7, s[20:23], s12 offen offset:2048 nt
    v_dot2c_f32_bf16_dpp v32, v40, v72 row_newbcast:6 row_mask:0xf bank_mask:0xf
    v_dot2c_f32_bf16_dpp v33, v41, v72 row_newbcast:6 row_mask:0xf bank_mask:0xf
    v_dot2c_f32_bf16_dpp v34, v40, v73 row_newbcast:6 row_mask:0xf bank_mask:0xf
    v_dot2c_f32_bf16_dpp v35, v41, v73 row_newbcast:6 row_mask:0xf bank_mask:0xf
    v_dot2c_f32_bf16_dpp v36, v40, v74 row_newbcast:6 row_mask:0xf bank_mask:0xf
    v_dot2c_f32_bf16_dpp v37, v41, v74 row_newbcast:6 row_mask:0xf bank_mask:0xf
    v_dot2c_f32_bf16_dpp v38, v40, v75 row_newbcast:6 row_mask:0xf bank_mask:0xf
    v_dot2c_f32_bf16_dpp v39, v41, v75 row_newbcast:6 row_mask:0xf bank_mask:0xf
    v_dot2c_f32_bf16_dpp v32, v40, v76 row_newbcast:7 row_mask:0xf bank_mask:0xf
    v_dot2c_f32_bf16_dpp v33, v41, v76 row_newbcast:7 row_mask:0xf bank_mask:0xf
    v_dot2c_f32_bf16_dpp v34, v40, v77 row_newbcast:7 row_mask:0xf bank_mask:0xf
    v_dot2c_f32_bf16_dpp v35, v41, v77 row_newbcast:7 row_mask:0xf bank_mask:0xf
    v_dot2c_f32_bf16_dpp v36, v40, v78 row_newbcast:7 row_mask:0xf bank_mask:0xf
    v_dot2c_f32_bf16_dpp v37, v41, v78 row_newbcast:7 row_mask:0xf bank_mask:0xf
    v_dot2c_f32_bf16_dpp v38, v40, v79 row_newbcast:7 row_mask:0xf bank_mask:0xf
    v_dot2c_f32_bf16_dpp v39, v41, v79 row_newbcast:7 row_mask:0xf bank_mask:0xf
    s_waitcnt vmcnt(4)
    buffer_load_dwordx4 v[104:107], v5, s[20:23], s12 offen offset:3072 nt
    buffer_load_dwordx4 v[108:111], v7, s[20:23], s12 offen offset:3072 nt
    v_dot2c_f32_bf16_dpp v32, v40, v80 row_newbcast:8 row_mask:0xf bank_mask:0xf
    v_dot2c_f32_bf16_dpp v33, v41, v80 row_newbcast:8 row_mask:0xf bank_mask:0xf
    v_dot2c_f32_bf16_dpp v34, v40, v81 row_newbcast:8 row_mask:0xf bank_mask:0xf
    v_dot2c_f32_bf16_dpp v35, v41, v81 row_newbcast:8 row_mask:0xf bank_mask:0xf
    v_dot2c_f32_bf16_dpp v36, v40, v82 row_newbcast:8 row_mask:0xf bank_mask:0xf
    v_dot2c_f32_bf16_dpp v37, v41, v82 row_newbcast:8 row_mask:0xf bank_mask:0xf
    v_dot2c_f32_bf16_dpp v38, v40, v83 row_newbcast:8 row_mask:0xf bank_mask:0xf
    v_dot2c_f32_bf16_dpp v39, v41, v83 row_newbcast:8 row_mask:0xf bank_mask:0xf
    v_dot2c_f32_bf16_dpp v32, v40, v84 row_newbcast:9 row_mask:0xf bank_mask:0xf
    v_dot2c_f32_bf16_dpp v33, v41, v84 row_newbcast:9 row_mask:0xf bank_mask:0xf
    v_dot2c_f32_bf16_dpp v34, v40, v85 row_newbcast:9 row_mask:0xf bank_mask:0xf
    v_dot2c_f32_bf16_dpp v35, v41, v85 row_newbcast:9 row_mask:0xf bank_mask:0xf
    v_dot2c_f32_bf16_dpp v36, v40, v86 row_newbcast:9 row_mask:0xf bank_mask:0xf
    v_dot2c_f32_bf16_dpp v37, v41, v86 row_newbcast:9 row_mask:0xf bank_mask:0xf
    v_dot2c_f32_bf16_dpp v38, v40, v87 row_newbcast:9 row_mask:0xf bank_mask:0xf
    v_dot2c_f32_bf16_dpp v39, v41, v87 row_newbcast:9 row_mask:0xf bank_mask:0xf
    s_waitcnt vmcnt(4)
    s_cmp_eq_u32 s98, -1
    s_cbranch_scc1 L_du_99
    s_and_b32 s6, s98, 127
    s_lshl2_add_u32 s6, s6, 145408
    v_mov_b32 v246, s6
    s_waitcnt lgkmcnt(0)
    v_mov_b32 v247, s99
    ds_write_b32 v246, v247
L_du_99:
    s_cmp_lg_u32 s85, 0
    s_cbranch_scc1 L_vp_94
    s_add_u32 s6, s96, s57
    s_lshr_b32 s7, s6, 2
    s_lshl_b32 s7, s7, 16
    s_and_b32 s13, s6, 3
    s_lshl_b32 s13, s13, 13
    s_or_b32 s13, s13, s7
    s_lshl_b32 s9, s57, 8
    s_add_u32 s9, s9, 99328
    s_cmp_ge_u32 s57, 96
    s_cselect_b32 s13, 0x7f000000, s13
    s_cselect_b32 s9, 144384, s9
    s_mov_b32 s8, 0x7f000000
    s_branch L_ve_95
L_vp_94:
    s_cmp_lg_u32 s85, 1
    s_cbranch_scc1 L_vc_98
    s_cmp_eq_u32 s84, 0
    s_cbranch_scc1 L_vc_98
    s_mov_b32 s84, 0
    s_lshl_b32 s6, s2, 10
    s_add_u32 s6, s6, 0x50040
    s_add_u32 s66, s28, s6
    s_addc_u32 s67, s29, 0
    s_mov_b32 s52, 0
L_sd_100:
    s_load_dword s68, s[66:67], 0x0 glc
    s_load_dword s69, s[66:67], 0x80 glc
    s_load_dword s70, s[66:67], 0x100 glc
    s_load_dword s71, s[66:67], 0x180 glc
    s_load_dword s72, s[66:67], 0x200 glc
    s_load_dword s73, s[66:67], 0x280 glc
    s_load_dword s74, s[66:67], 0x300 glc
    s_load_dword s75, s[66:67], 0x380 glc
    s_add_u32 s52, s52, 1
    s_cmp_gt_u32 s52, 0x80000
    s_cbranch_scc1 L_end
    s_waitcnt lgkmcnt(0)
    s_xor_b32 s6, s68, s11
    s_xor_b32 s7, s69, s11
    s_or_b32 s6, s6, s7
    s_xor_b32 s7, s70, s11
    s_or_b32 s6, s6, s7
    s_xor_b32 s7, s71, s11
    s_or_b32 s6, s6, s7
    s_xor_b32 s7, s72, s11
    s_or_b32 s6, s6, s7
    s_xor_b32 s7, s73, s11
    s_or_b32 s6, s6, s7
    s_xor_b32 s7, s74, s11
    s_or_b32 s6, s6, s7
    s_xor_b32 s7, s75, s11
    s_or_b32 s6, s6, s7
    s_cmp_lg_u32 s6, 0
    s_cbranch_scc1 L_sd_100
L_vc_98:
    s_cmp_eq_u32 s85, 2
    s_cbranch_scc1 L_vn_96
    s_sub_u32 s9, s57, 96
    s_and_b32 s6, s9, 0x1fc
    s_add_u32 s6, s6, 145408
    v_mov_b32 v246, s6
    s_mov_b32 s52, 0
L_rt_101:
    ds_read_b32 v247, v246
    s_add_u32 s52, s52, 1
    s_cmp_gt_u32 s52, 0x800000
    s_cbranch_scc1 L_end
    s_waitcnt lgkmcnt(0)
    v_readfirstlane_b32 s8, v247
    s_nop 0
    s_cmp_eq_u32 s8, -1
    s_cbranch_scc1 L_rt_101
    s_cmp_ge_u32 s8, 64
    s_cbranch_scc1 L_vn_96
    s_and_b32 s9, s9, 3
    s_lshl2_add_u32 s9, s8, s9
    s_mul_i32 s7, s9, 32769
    s_lshr_b32 s7, s7, 20
    s_mul_i32 s7, s7, 96
    s_add_u32 s6, s9, s7
    s_add_u32 s6, s6, 96
    s_lshr_b32 s7, s6, 2
    s_lshl_b32 s7, s7, 16
    s_and_b32 s13, s6, 3
    s_lshl_b32 s13, s13, 13
    s_or_b32 s13, s13, s7
    s_mov_b32 s9, 144384
    s_cmp_lt_u32 s8, 58
    s_cselect_b32 s7, 1, 0
    s_lshl_b32 s8, s6, 7
    s_cmp_lg_u32 s7, 0
    s_cbranch_scc1 L_ve_95
    s_branch L_vf_97
L_vn_96:
    s_mov_b32 s15, 1
    s_mov_b32 s13, 0x7f000000
    s_mov_b32 s8, 0x7f000000
    s_mov_b32 s9, 144384
L_vf_97:
    s_cmp_lg_u32 s62, 0
    s_cbranch_scc1 L_ve_95
    v_mov_b32 v246, 348
    v_mov_b32 v247, 1
    ds_or_b32 v246, v247
L_ve_95:
    buffer_load_ushort v243, v15, s[36:39], s8 offen sc1
    v_add_u32 v242, s9, v240
    ds_read_b32 v242, v242
    buffer_load_dwordx4 v[48:51], v4, s[20:23], s13 offen offset:0 nt
    buffer_load_dwordx4 v[52:55], v6, s[20:23], s13 offen offset:0 nt
    v_dot2c_f32_bf16_dpp v32, v40, v88 row_newbcast:10 row_mask:0xf bank_mask:0xf
    v_dot2c_f32_bf16_dpp v33, v41, v88 row_newbcast:10 row_mask:0xf bank_mask:0xf
    v_dot2c_f32_bf16_dpp v34, v40, v89 row_newbcast:10 row_mask:0xf bank_mask:0xf
    v_dot2c_f32_bf16_dpp v35, v41, v89 row_newbcast:10 row_mask:0xf bank_mask:0xf
    v_dot2c_f32_bf16_dpp v36, v40, v90 row_newbcast:10 row_mask:0xf bank_mask:0xf
    v_dot2c_f32_bf16_dpp v37, v41, v90 row_newbcast:10 row_mask:0xf bank_mask:0xf
    v_dot2c_f32_bf16_dpp v38, v40, v91 row_newbcast:10 row_mask:0xf bank_mask:0xf
    v_dot2c_f32_bf16_dpp v39, v41, v91 row_newbcast:10 row_mask:0xf bank_mask:0xf
    v_dot2c_f32_bf16_dpp v32, v40, v92 row_newbcast:11 row_mask:0xf bank_mask:0xf
    v_dot2c_f32_bf16_dpp v33, v41, v92 row_newbcast:11 row_mask:0xf bank_mask:0xf
    v_dot2c_f32_bf16_dpp v34, v40, v93 row_newbcast:11 row_mask:0xf bank_mask:0xf
    v_dot2c_f32_bf16_dpp v35, v41, v93 row_newbcast:11 row_mask:0xf bank_mask:0xf
    v_dot2c_f32_bf16_dpp v36, v40, v94 row_newbcast:11 row_mask:0xf bank_mask:0xf
    v_dot2c_f32_bf16_dpp v37, v41, v94 row_newbcast:11 row_mask:0xf bank_mask:0xf
    v_dot2c_f32_bf16_dpp v38, v40, v95 row_newbcast:11 row_mask:0xf bank_mask:0xf
    v_dot2c_f32_bf16_dpp v39, v41, v95 row_newbcast:11 row_mask:0xf bank_mask:0xf
    s_waitcnt vmcnt(5)
    buffer_load_dwordx4 v[56:59], v4, s[20:23], s13 offen offset:1024 nt
    buffer_load_dwordx4 v[60:63], v6, s[20:23], s13 offen offset:1024 nt
    v_dot2c_f32_bf16_dpp v32, v40, v96 row_newbcast:12 row_mask:0xf bank_mask:0xf
    v_dot2c_f32_bf16_dpp v33, v41, v96 row_newbcast:12 row_mask:0xf bank_mask:0xf
    v_dot2c_f32_bf16_dpp v34, v40, v97 row_newbcast:12 row_mask:0xf bank_mask:0xf
    v_dot2c_f32_bf16_dpp v35, v41, v97 row_newbcast:12 row_mask:0xf bank_mask:0xf
    v_dot2c_f32_bf16_dpp v36, v40, v98 row_newbcast:12 row_mask:0xf bank_mask:0xf
    v_dot2c_f32_bf16_dpp v37, v41, v98 row_newbcast:12 row_mask:0xf bank_mask:0xf
    v_dot2c_f32_bf16_dpp v38, v40, v99 row_newbcast:12 row_mask:0xf bank_mask:0xf
    v_dot2c_f32_bf16_dpp v39, v41, v99 row_newbcast:12 row_mask:0xf bank_mask:0xf
    v_dot2c_f32_bf16_dpp v32, v40, v100 row_newbcast:13 row_mask:0xf bank_mask:0xf
    v_dot2c_f32_bf16_dpp v33, v41, v100 row_newbcast:13 row_mask:0xf bank_mask:0xf
    v_dot2c_f32_bf16_dpp v34, v40, v101 row_newbcast:13 row_mask:0xf bank_mask:0xf
    v_dot2c_f32_bf16_dpp v35, v41, v101 row_newbcast:13 row_mask:0xf bank_mask:0xf
    v_dot2c_f32_bf16_dpp v36, v40, v102 row_newbcast:13 row_mask:0xf bank_mask:0xf
    v_dot2c_f32_bf16_dpp v37, v41, v102 row_newbcast:13 row_mask:0xf bank_mask:0xf
    v_dot2c_f32_bf16_dpp v38, v40, v103 row_newbcast:13 row_mask:0xf bank_mask:0xf
    v_dot2c_f32_bf16_dpp v39, v41, v103 row_newbcast:13 row_mask:0xf bank_mask:0xf
    s_waitcnt vmcnt(5)
    buffer_load_dwordx4 v[64:67], v4, s[20:23], s13 offen offset:2048 nt
    buffer_load_dwordx4 v[68:71], v6, s[20:23], s13 offen offset:2048 nt
    v_dot2c_f32_bf16_dpp v32, v40, v104 row_newbcast:14 row_mask:0xf bank_mask:0xf
    v_dot2c_f32_bf16_dpp v33, v41, v104 row_newbcast:14 row_mask:0xf bank_mask:0xf
    v_dot2c_f32_bf16_dpp v34, v40, v105 row_newbcast:14 row_mask:0xf bank_mask:0xf
    v_dot2c_f32_bf16_dpp v35, v41, v105 row_newbcast:14 row_mask:0xf bank_mask:0xf
    v_dot2c_f32_bf16_dpp v36, v40, v106 row_newbcast:14 row_mask:0xf bank_mask:0xf
    v_dot2c_f32_bf16_dpp v37, v41, v106 row_newbcast:14 row_mask:0xf bank_mask:0xf
    v_dot2c_f32_bf16_dpp v38, v40, v107 row_newbcast:14 row_mask:0xf bank_mask:0xf
    v_dot2c_f32_bf16_dpp v39, v41, v107 row_newbcast:14 row_mask:0xf bank_mask:0xf
    v_dot2c_f32_bf16_dpp v32, v40, v108 row_newbcast:15 row_mask:0xf bank_mask:0xf
    v_dot2c_f32_bf16_dpp v33, v41, v108 row_newbcast:15 row_mask:0xf bank_mask:0xf
    v_dot2c_f32_bf16_dpp v34, v40, v109 row_newbcast:15 row_mask:0xf bank_mask:0xf
    v_dot2c_f32_bf16_dpp v35, v41, v109 row_newbcast:15 row_mask:0xf bank_mask:0xf
    v_dot2c_f32_bf16_dpp v36, v40, v110 row_newbcast:15 row_mask:0xf bank_mask:0xf
    v_dot2c_f32_bf16_dpp v37, v41, v110 row_newbcast:15 row_mask:0xf bank_mask:0xf
    v_dot2c_f32_bf16_dpp v38, v40, v111 row_newbcast:15 row_mask:0xf bank_mask:0xf
    v_dot2c_f32_bf16_dpp v39, v41, v111 row_newbcast:15 row_mask:0xf bank_mask:0xf
    s_mov_b32 s12, s13
    s_cmp_eq_u32 s15, 0
    s_cbranch_scc1 L_vloop
    s_branch L_vdone
L_v_lastB:
    v_add_u32 v42, s89, v240
    ds_read_b32 v42, v42
    s_waitcnt lgkmcnt(0)
    v_subrev_f32 v42, s50, v42
    v_mul_f32 v42, s46, v42
    v_exp_f32 v42, v42
    s_nop 0
    v_mul_f32 v42, s51, v42
    v_min_f32 v42, 1.0, v42
    v_cvt_pk_bf16_f32 v42, v42, 0
    v_lshlrev_b32 v43, 16, v42
    s_nop 1
    v_dot2c_f32_bf16_dpp v32, v42, v176 row_newbcast:0 row_mask:0xf bank_mask:0xf
    v_dot2c_f32_bf16_dpp v33, v43, v176 row_newbcast:0 row_mask:0xf bank_mask:0xf
    v_dot2c_f32_bf16_dpp v34, v42, v177 row_newbcast:0 row_mask:0xf bank_mask:0xf
    v_dot2c_f32_bf16_dpp v35, v43, v177 row_newbcast:0 row_mask:0xf bank_mask:0xf
    v_dot2c_f32_bf16_dpp v36, v42, v178 row_newbcast:0 row_mask:0xf bank_mask:0xf
    v_dot2c_f32_bf16_dpp v37, v43, v178 row_newbcast:0 row_mask:0xf bank_mask:0xf
    v_dot2c_f32_bf16_dpp v38, v42, v179 row_newbcast:0 row_mask:0xf bank_mask:0xf
    v_dot2c_f32_bf16_dpp v39, v43, v179 row_newbcast:0 row_mask:0xf bank_mask:0xf
    v_dot2c_f32_bf16_dpp v32, v42, v180 row_newbcast:1 row_mask:0xf bank_mask:0xf
    v_dot2c_f32_bf16_dpp v33, v43, v180 row_newbcast:1 row_mask:0xf bank_mask:0xf
    v_dot2c_f32_bf16_dpp v34, v42, v181 row_newbcast:1 row_mask:0xf bank_mask:0xf
    v_dot2c_f32_bf16_dpp v35, v43, v181 row_newbcast:1 row_mask:0xf bank_mask:0xf
    v_dot2c_f32_bf16_dpp v36, v42, v182 row_newbcast:1 row_mask:0xf bank_mask:0xf
    v_dot2c_f32_bf16_dpp v37, v43, v182 row_newbcast:1 row_mask:0xf bank_mask:0xf
    v_dot2c_f32_bf16_dpp v38, v42, v183 row_newbcast:1 row_mask:0xf bank_mask:0xf
    v_dot2c_f32_bf16_dpp v39, v43, v183 row_newbcast:1 row_mask:0xf bank_mask:0xf
    v_dot2c_f32_bf16_dpp v32, v42, v184 row_newbcast:2 row_mask:0xf bank_mask:0xf
    v_dot2c_f32_bf16_dpp v33, v43, v184 row_newbcast:2 row_mask:0xf bank_mask:0xf
    v_dot2c_f32_bf16_dpp v34, v42, v185 row_newbcast:2 row_mask:0xf bank_mask:0xf
    v_dot2c_f32_bf16_dpp v35, v43, v185 row_newbcast:2 row_mask:0xf bank_mask:0xf
    v_dot2c_f32_bf16_dpp v36, v42, v186 row_newbcast:2 row_mask:0xf bank_mask:0xf
    v_dot2c_f32_bf16_dpp v37, v43, v186 row_newbcast:2 row_mask:0xf bank_mask:0xf
    v_dot2c_f32_bf16_dpp v38, v42, v187 row_newbcast:2 row_mask:0xf bank_mask:0xf
    v_dot2c_f32_bf16_dpp v39, v43, v187 row_newbcast:2 row_mask:0xf bank_mask:0xf
    v_dot2c_f32_bf16_dpp v32, v42, v188 row_newbcast:3 row_mask:0xf bank_mask:0xf
    v_dot2c_f32_bf16_dpp v33, v43, v188 row_newbcast:3 row_mask:0xf bank_mask:0xf
    v_dot2c_f32_bf16_dpp v34, v42, v189 row_newbcast:3 row_mask:0xf bank_mask:0xf
    v_dot2c_f32_bf16_dpp v35, v43, v189 row_newbcast:3 row_mask:0xf bank_mask:0xf
    v_dot2c_f32_bf16_dpp v36, v42, v190 row_newbcast:3 row_mask:0xf bank_mask:0xf
    v_dot2c_f32_bf16_dpp v37, v43, v190 row_newbcast:3 row_mask:0xf bank_mask:0xf
    v_dot2c_f32_bf16_dpp v38, v42, v191 row_newbcast:3 row_mask:0xf bank_mask:0xf
    v_dot2c_f32_bf16_dpp v39, v43, v191 row_newbcast:3 row_mask:0xf bank_mask:0xf
    v_dot2c_f32_bf16_dpp v32, v42, v192 row_newbcast:4 row_mask:0xf bank_mask:0xf
    v_dot2c_f32_bf16_dpp v33, v43, v192 row_newbcast:4 row_mask:0xf bank_mask:0xf
    v_dot2c_f32_bf16_dpp v34, v42, v193 row_newbcast:4 row_mask:0xf bank_mask:0xf
    v_dot2c_f32_bf16_dpp v35, v43, v193 row_newbcast:4 row_mask:0xf bank_mask:0xf
    v_dot2c_f32_bf16_dpp v36, v42, v194 row_newbcast:4 row_mask:0xf bank_mask:0xf
    v_dot2c_f32_bf16_dpp v37, v43, v194 row_newbcast:4 row_mask:0xf bank_mask:0xf
    v_dot2c_f32_bf16_dpp v38, v42, v195 row_newbcast:4 row_mask:0xf bank_mask:0xf
    v_dot2c_f32_bf16_dpp v39, v43, v195 row_newbcast:4 row_mask:0xf bank_mask:0xf
    v_dot2c_f32_bf16_dpp v32, v42, v196 row_newbcast:5 row_mask:0xf bank_mask:0xf
    v_dot2c_f32_bf16_dpp v33, v43, v196 row_newbcast:5 row_mask:0xf bank_mask:0xf
    v_dot2c_f32_bf16_dpp v34, v42, v197 row_newbcast:5 row_mask:0xf bank_mask:0xf
    v_dot2c_f32_bf16_dpp v35, v43, v197 row_newbcast:5 row_mask:0xf bank_mask:0xf
    v_dot2c_f32_bf16_dpp v36, v42, v198 row_newbcast:5 row_mask:0xf bank_mask:0xf
    v_dot2c_f32_bf16_dpp v37, v43, v198 row_newbcast:5 row_mask:0xf bank_mask:0xf
    v_dot2c_f32_bf16_dpp v38, v42, v199 row_newbcast:5 row_mask:0xf bank_mask:0xf
    v_dot2c_f32_bf16_dpp v39, v43, v199 row_newbcast:5 row_mask:0xf bank_mask:0xf
    v_dot2c_f32_bf16_dpp v32, v42, v200 row_newbcast:6 row_mask:0xf bank_mask:0xf
    v_dot2c_f32_bf16_dpp v33, v43, v200 row_newbcast:6 row_mask:0xf bank_mask:0xf
    v_dot2c_f32_bf16_dpp v34, v42, v201 row_newbcast:6 row_mask:0xf bank_mask:0xf
    v_dot2c_f32_bf16_dpp v35, v43, v201 row_newbcast:6 row_mask:0xf bank_mask:0xf
    v_dot2c_f32_bf16_dpp v36, v42, v202 row_newbcast:6 row_mask:0xf bank_mask:0xf
    v_dot2c_f32_bf16_dpp v37, v43, v202 row_newbcast:6 row_mask:0xf bank_mask:0xf
    v_dot2c_f32_bf16_dpp v38, v42, v203 row_newbcast:6 row_mask:0xf bank_mask:0xf
    v_dot2c_f32_bf16_dpp v39, v43, v203 row_newbcast:6 row_mask:0xf bank_mask:0xf
    v_dot2c_f32_bf16_dpp v32, v42, v204 row_newbcast:7 row_mask:0xf bank_mask:0xf
    v_dot2c_f32_bf16_dpp v33, v43, v204 row_newbcast:7 row_mask:0xf bank_mask:0xf
    v_dot2c_f32_bf16_dpp v34, v42, v205 row_newbcast:7 row_mask:0xf bank_mask:0xf
    v_dot2c_f32_bf16_dpp v35, v43, v205 row_newbcast:7 row_mask:0xf bank_mask:0xf
    v_dot2c_f32_bf16_dpp v36, v42, v206 row_newbcast:7 row_mask:0xf bank_mask:0xf
    v_dot2c_f32_bf16_dpp v37, v43, v206 row_newbcast:7 row_mask:0xf bank_mask:0xf
    v_dot2c_f32_bf16_dpp v38, v42, v207 row_newbcast:7 row_mask:0xf bank_mask:0xf
    v_dot2c_f32_bf16_dpp v39, v43, v207 row_newbcast:7 row_mask:0xf bank_mask:0xf
    v_dot2c_f32_bf16_dpp v32, v42, v208 row_newbcast:8 row_mask:0xf bank_mask:0xf
    v_dot2c_f32_bf16_dpp v33, v43, v208 row_newbcast:8 row_mask:0xf bank_mask:0xf
    v_dot2c_f32_bf16_dpp v34, v42, v209 row_newbcast:8 row_mask:0xf bank_mask:0xf
    v_dot2c_f32_bf16_dpp v35, v43, v209 row_newbcast:8 row_mask:0xf bank_mask:0xf
    v_dot2c_f32_bf16_dpp v36, v42, v210 row_newbcast:8 row_mask:0xf bank_mask:0xf
    v_dot2c_f32_bf16_dpp v37, v43, v210 row_newbcast:8 row_mask:0xf bank_mask:0xf
    v_dot2c_f32_bf16_dpp v38, v42, v211 row_newbcast:8 row_mask:0xf bank_mask:0xf
    v_dot2c_f32_bf16_dpp v39, v43, v211 row_newbcast:8 row_mask:0xf bank_mask:0xf
    v_dot2c_f32_bf16_dpp v32, v42, v212 row_newbcast:9 row_mask:0xf bank_mask:0xf
    v_dot2c_f32_bf16_dpp v33, v43, v212 row_newbcast:9 row_mask:0xf bank_mask:0xf
    v_dot2c_f32_bf16_dpp v34, v42, v213 row_newbcast:9 row_mask:0xf bank_mask:0xf
    v_dot2c_f32_bf16_dpp v35, v43, v213 row_newbcast:9 row_mask:0xf bank_mask:0xf
    v_dot2c_f32_bf16_dpp v36, v42, v214 row_newbcast:9 row_mask:0xf bank_mask:0xf
    v_dot2c_f32_bf16_dpp v37, v43, v214 row_newbcast:9 row_mask:0xf bank_mask:0xf
    v_dot2c_f32_bf16_dpp v38, v42, v215 row_newbcast:9 row_mask:0xf bank_mask:0xf
    v_dot2c_f32_bf16_dpp v39, v43, v215 row_newbcast:9 row_mask:0xf bank_mask:0xf
    v_dot2c_f32_bf16_dpp v32, v42, v216 row_newbcast:10 row_mask:0xf bank_mask:0xf
    v_dot2c_f32_bf16_dpp v33, v43, v216 row_newbcast:10 row_mask:0xf bank_mask:0xf
    v_dot2c_f32_bf16_dpp v34, v42, v217 row_newbcast:10 row_mask:0xf bank_mask:0xf
    v_dot2c_f32_bf16_dpp v35, v43, v217 row_newbcast:10 row_mask:0xf bank_mask:0xf
    v_dot2c_f32_bf16_dpp v36, v42, v218 row_newbcast:10 row_mask:0xf bank_mask:0xf
    v_dot2c_f32_bf16_dpp v37, v43, v218 row_newbcast:10 row_mask:0xf bank_mask:0xf
    v_dot2c_f32_bf16_dpp v38, v42, v219 row_newbcast:10 row_mask:0xf bank_mask:0xf
    v_dot2c_f32_bf16_dpp v39, v43, v219 row_newbcast:10 row_mask:0xf bank_mask:0xf
    v_dot2c_f32_bf16_dpp v32, v42, v220 row_newbcast:11 row_mask:0xf bank_mask:0xf
    v_dot2c_f32_bf16_dpp v33, v43, v220 row_newbcast:11 row_mask:0xf bank_mask:0xf
    v_dot2c_f32_bf16_dpp v34, v42, v221 row_newbcast:11 row_mask:0xf bank_mask:0xf
    v_dot2c_f32_bf16_dpp v35, v43, v221 row_newbcast:11 row_mask:0xf bank_mask:0xf
    v_dot2c_f32_bf16_dpp v36, v42, v222 row_newbcast:11 row_mask:0xf bank_mask:0xf
    v_dot2c_f32_bf16_dpp v37, v43, v222 row_newbcast:11 row_mask:0xf bank_mask:0xf
    v_dot2c_f32_bf16_dpp v38, v42, v223 row_newbcast:11 row_mask:0xf bank_mask:0xf
    v_dot2c_f32_bf16_dpp v39, v43, v223 row_newbcast:11 row_mask:0xf bank_mask:0xf
    v_dot2c_f32_bf16_dpp v32, v42, v224 row_newbcast:12 row_mask:0xf bank_mask:0xf
    v_dot2c_f32_bf16_dpp v33, v43, v224 row_newbcast:12 row_mask:0xf bank_mask:0xf
    v_dot2c_f32_bf16_dpp v34, v42, v225 row_newbcast:12 row_mask:0xf bank_mask:0xf
    v_dot2c_f32_bf16_dpp v35, v43, v225 row_newbcast:12 row_mask:0xf bank_mask:0xf
    v_dot2c_f32_bf16_dpp v36, v42, v226 row_newbcast:12 row_mask:0xf bank_mask:0xf
    v_dot2c_f32_bf16_dpp v37, v43, v226 row_newbcast:12 row_mask:0xf bank_mask:0xf
    v_dot2c_f32_bf16_dpp v38, v42, v227 row_newbcast:12 row_mask:0xf bank_mask:0xf
    v_dot2c_f32_bf16_dpp v39, v43, v227 row_newbcast:12 row_mask:0xf bank_mask:0xf
    v_dot2c_f32_bf16_dpp v32, v42, v228 row_newbcast:13 row_mask:0xf bank_mask:0xf
    v_dot2c_f32_bf16_dpp v33, v43, v228 row_newbcast:13 row_mask:0xf bank_mask:0xf
    v_dot2c_f32_bf16_dpp v34, v42, v229 row_newbcast:13 row_mask:0xf bank_mask:0xf
    v_dot2c_f32_bf16_dpp v35, v43, v229 row_newbcast:13 row_mask:0xf bank_mask:0xf
    v_dot2c_f32_bf16_dpp v36, v42, v230 row_newbcast:13 row_mask:0xf bank_mask:0xf
    v_dot2c_f32_bf16_dpp v37, v43, v230 row_newbcast:13 row_mask:0xf bank_mask:0xf
    v_dot2c_f32_bf16_dpp v38, v42, v231 row_newbcast:13 row_mask:0xf bank_mask:0xf
    v_dot2c_f32_bf16_dpp v39, v43, v231 row_newbcast:13 row_mask:0xf bank_mask:0xf
    v_dot2c_f32_bf16_dpp v32, v42, v232 row_newbcast:14 row_mask:0xf bank_mask:0xf
    v_dot2c_f32_bf16_dpp v33, v43, v232 row_newbcast:14 row_mask:0xf bank_mask:0xf
    v_dot2c_f32_bf16_dpp v34, v42, v233 row_newbcast:14 row_mask:0xf bank_mask:0xf
    v_dot2c_f32_bf16_dpp v35, v43, v233 row_newbcast:14 row_mask:0xf bank_mask:0xf
    v_dot2c_f32_bf16_dpp v36, v42, v234 row_newbcast:14 row_mask:0xf bank_mask:0xf
    v_dot2c_f32_bf16_dpp v37, v43, v234 row_newbcast:14 row_mask:0xf bank_mask:0xf
    v_dot2c_f32_bf16_dpp v38, v42, v235 row_newbcast:14 row_mask:0xf bank_mask:0xf
    v_dot2c_f32_bf16_dpp v39, v43, v235 row_newbcast:14 row_mask:0xf bank_mask:0xf
    v_dot2c_f32_bf16_dpp v32, v42, v236 row_newbcast:15 row_mask:0xf bank_mask:0xf
    v_dot2c_f32_bf16_dpp v33, v43, v236 row_newbcast:15 row_mask:0xf bank_mask:0xf
    v_dot2c_f32_bf16_dpp v34, v42, v237 row_newbcast:15 row_mask:0xf bank_mask:0xf
    v_dot2c_f32_bf16_dpp v35, v43, v237 row_newbcast:15 row_mask:0xf bank_mask:0xf
    v_dot2c_f32_bf16_dpp v36, v42, v238 row_newbcast:15 row_mask:0xf bank_mask:0xf
    v_dot2c_f32_bf16_dpp v37, v43, v238 row_newbcast:15 row_mask:0xf bank_mask:0xf
    v_dot2c_f32_bf16_dpp v38, v42, v239 row_newbcast:15 row_mask:0xf bank_mask:0xf
    v_dot2c_f32_bf16_dpp v39, v43, v239 row_newbcast:15 row_mask:0xf bank_mask:0xf
L_vdone:
    s_cmp_eq_u32 s62, 0
    s_cbranch_scc1 L_vfin
    v_mov_b32 v3, 348
    s_mov_b32 s52, 0
L_wf_102:
    ds_read_b32 v2, v3
    s_add_u32 s52, s52, 1
    s_cmp_gt_u32 s52, 0x800000
    s_cbranch_scc1 L_end
    s_waitcnt lgkmcnt(0)
    v_readfirstlane_b32 s6, v2
    s_nop 0
    s_cmp_lg_u32 s6, 0
    s_cbranch_scc1 L_wfd_103
    s_sleep 8
    s_branch L_wf_102
L_wfd_103:
    s_mov_b32 s62, 0
    s_mov_b32 s15, 0
    s_mov_b32 s98, -1
    v_mov_b32 v246, 324
    s_mov_b64 exec, 1
    ds_add_rtn_u32 v247, v246, v241
    s_mov_b64 exec, -1
    s_waitcnt lgkmcnt(0)
    v_readfirstlane_b32 s57, v247
    s_nop 0
    s_cmp_ge_u32 s57, 96
    s_cselect_b32 s85, 1, 0
    s_sub_u32 s6, s57, 93
    s_cbranch_scc1 L_rd_104
    s_and_b32 s7, s6, 3
    s_cbranch_scc1 L_rd_104
    s_lshr_b32 s98, s6, 2
    s_cmp_eq_u32 s98, 0
    s_cbranch_scc1 L_ro_107
    s_and_b32 s6, s6, 0x1fc
    s_add_u32 s6, s6, 145404
    v_mov_b32 v246, s6
    s_mov_b32 s52, 0
L_rw_106:
    ds_read_b32 v247, v246
    s_add_u32 s52, s52, 1
    s_cmp_gt_u32 s52, 0x800000
    s_cbranch_scc1 L_end
    s_waitcnt lgkmcnt(0)
    v_readfirstlane_b32 s7, v247
    s_nop 0
    s_cmp_eq_u32 s7, -1
    s_cbranch_scc1 L_rw_106
L_ro_107:
    s_mov_b32 s99, 1
    s_atomic_add s99, s[40:41], 0x80 glc
L_rd_104:
    s_cmp_eq_u32 s98, -1
    s_cbranch_scc1 L_du_113
    s_and_b32 s6, s98, 127
    s_lshl2_add_u32 s6, s6, 145408
    v_mov_b32 v246, s6
    s_waitcnt lgkmcnt(0)
    v_mov_b32 v247, s99
    ds_write_b32 v246, v247
L_du_113:
    s_cmp_lg_u32 s85, 0
    s_cbranch_scc1 L_vp_108
    s_add_u32 s6, s96, s57
    s_lshr_b32 s7, s6, 2
    s_lshl_b32 s7, s7, 16
    s_and_b32 s13, s6, 3
    s_lshl_b32 s13, s13, 13
    s_or_b32 s13, s13, s7
    s_lshl_b32 s9, s57, 8
    s_add_u32 s9, s9, 99328
    s_cmp_ge_u32 s57, 96
    s_cselect_b32 s13, 0x7f000000, s13
    s_cselect_b32 s9, 144384, s9
    s_mov_b32 s8, 0x7f000000
    s_branch L_ve_109
L_vp_108:
    s_cmp_lg_u32 s85, 1
    s_cbranch_scc1 L_vc_112
    s_cmp_eq_u32 s84, 0
    s_cbranch_scc1 L_vc_112
    s_mov_b32 s84, 0
    s_lshl_b32 s6, s2, 10
    s_add_u32 s6, s6, 0x50040
    s_add_u32 s66, s28, s6
    s_addc_u32 s67, s29, 0
    s_mov_b32 s52, 0
L_sd_114:
    s_load_dword s68, s[66:67], 0x0 glc
    s_load_dword s69, s[66:67], 0x80 glc
    s_load_dword s70, s[66:67], 0x100 glc
    s_load_dword s71, s[66:67], 0x180 glc
    s_load_dword s72, s[66:67], 0x200 glc
    s_load_dword s73, s[66:67], 0x280 glc
    s_load_dword s74, s[66:67], 0x300 glc
    s_load_dword s75, s[66:67], 0x380 glc
    s_add_u32 s52, s52, 1
    s_cmp_gt_u32 s52, 0x80000
    s_cbranch_scc1 L_end
    s_waitcnt lgkmcnt(0)
    s_xor_b32 s6, s68, s11
    s_xor_b32 s7, s69, s11
    s_or_b32 s6, s6, s7
    s_xor_b32 s7, s70, s11
    s_or_b32 s6, s6, s7
    s_xor_b32 s7, s71, s11
    s_or_b32 s6, s6, s7
    s_xor_b32 s7, s72, s11
    s_or_b32 s6, s6, s7
    s_xor_b32 s7, s73, s11
    s_or_b32 s6, s6, s7
    s_xor_b32 s7, s74, s11
    s_or_b32 s6, s6, s7
    s_xor_b32 s7, s75, s11
    s_or_b32 s6, s6, s7
    s_cmp_lg_u32 s6, 0
    s_cbranch_scc1 L_sd_114
L_vc_112:
    s_cmp_eq_u32 s85, 2
    s_cbranch_scc1 L_vn_110
    s_sub_u32 s9, s57, 96
    s_and_b32 s6, s9, 0x1fc
    s_add_u32 s6, s6, 145408
    v_mov_b32 v246, s6
    s_mov_b32 s52, 0
L_rt_115:
    ds_read_b32 v247, v246
    s_add_u32 s52, s52, 1
    s_cmp_gt_u32 s52, 0x800000
    s_cbranch_scc1 L_end
    s_waitcnt lgkmcnt(0)
    v_readfirstlane_b32 s8, v247
    s_nop 0
    s_cmp_eq_u32 s8, -1
    s_cbranch_scc1 L_rt_115
    s_cmp_ge_u32 s8, 64
    s_cbranch_scc1 L_vn_110
    s_and_b32 s9, s9, 3
    s_lshl2_add_u32 s9, s8, s9
    s_mul_i32 s7, s9, 32769
    s_lshr_b32 s7, s7, 20
    s_mul_i32 s7, s7, 96
    s_add_u32 s6, s9, s7
    s_add_u32 s6, s6, 96
    s_lshr_b32 s7, s6, 2
    s_lshl_b32 s7, s7, 16
    s_and_b32 s13, s6, 3
    s_lshl_b32 s13, s13, 13
    s_or_b32 s13, s13, s7
    s_mov_b32 s9, 144384
    s_cmp_lt_u32 s8, 58
    s_cselect_b32 s7, 1, 0
    s_lshl_b32 s8, s6, 7
    s_cmp_lg_u32 s7, 0
    s_cbranch_scc1 L_ve_109
    s_branch L_vf_111
L_vn_110:
    s_mov_b32 s15, 1
    s_mov_b32 s13, 0x7f000000
    s_mov_b32 s8, 0x7f000000
    s_mov_b32 s9, 144384
L_vf_111:
L_ve_109:
    buffer_load_ushort v243, v15, s[36:39], s8 offen sc1
    v_add_u32 v242, s9, v240
    ds_read_b32 v242, v242
    s_cmp_lg_u32 s15, 0
    s_cbranch_scc1 L_vfin
    s_mov_b32 s12, s13
    buffer_load_dwordx4 v[48:51], v4, s[20:23], s12 offen offset:0 nt
    buffer_load_dwordx4 v[52:55], v6, s[20:23], s12 offen offset:0 nt
    buffer_load_dwordx4 v[56:59], v4, s[20:23], s12 offen offset:1024 nt
    buffer_load_dwordx4 v[60:63], v6, s[20:23], s12 offen offset:1024 nt
    buffer_load_dwordx4 v[64:67], v4, s[20:23], s12 offen offset:2048 nt
    buffer_load_dwordx4 v[68:71], v6, s[20:23], s12 offen offset:2048 nt
    s_branch L_vloop
L_vfin:
    v_lshlrev_b32 v3, 3, v0
    s_nop 2
    v_permlane32_swap_b32 v32, v36
    v_permlane32_swap_b32 v33, v37
    v_permlane32_swap_b32 v34, v38
    v_permlane32_swap_b32 v35, v39
    s_nop 0
    v_add_f32 v32, v32, v36
    v_add_f32 v33, v33, v37
    v_add_f32 v34, v34, v38
    v_add_f32 v35, v35, v39
    s_nop 1
    v_permlane16_swap_b32 v32, v34
    v_permlane16_swap_b32 v33, v35
    s_nop 0
    v_add_f32 v32, v32, v34
    v_add_f32 v33, v33, v35
    ds_write_b64 v251, v[32:33] offset:1024
    s_waitcnt lgkmcnt(0)
    s_barrier
    ds_read_b64 v[16:17], v3 offset:1024
    ds_read_b64 v[18:19], v3 offset:3072
    ds_read_b64 v[20:21], v3 offset:5120
    ds_read_b64 v[22:23], v3 offset:7168
    ds_read_b64 v[24:25], v3 offset:9216
    ds_read_b64 v[26:27], v3 offset:11264
    ds_read_b64 v[28:29], v3 offset:13312
    ds_read_b64 v[30:31], v3 offset:15360
    v_add_u32 v1, 0x200000, v4
    s_lshl_b32 s6, s4, 3
    s_add_u32 s6, s6, s3
    s_lshl_b32 s6, s6, 13
    s_lshl_b32 s7, s5, 10
    s_add_u32 s6, s6, s7
    s_waitcnt lgkmcnt(0)
    v_add_f32 v16, v16, v24
    v_add_f32 v17, v17, v25
    v_add_f32 v18, v18, v26
    v_add_f32 v19, v19, v27
    v_add_f32 v20, v20, v28
    v_add_f32 v21, v21, v29
    v_add_f32 v22, v22, v30
    v_add_f32 v23, v23, v31
    v_add_f32 v16, v16, v20
    v_add_f32 v17, v17, v21
    v_add_f32 v18, v18, v22
    v_add_f32 v19, v19, v23
    v_add_f32 v16, v16, v18
    v_add_f32 v17, v17, v19
    v_mov_b32 v18, v17
    v_mov_b32 v17, s11
    v_mov_b32 v19, s11
    buffer_store_dwordx4 v[16:19], v1, s[28:31], s6 offen sc1
    v_and_b32 v1, 31, v0
    v_lshlrev_b32 v1, 2, v1
    v_lshrrev_b32 v2, 5, v0
    v_lshl_add_u32 v1, v2, 10, v1
    s_lshl_b32 s6, s3, 11
    s_add_u32 s6, s6, 25600
    v_add_u32 v40, s6, v1
    ds_read_b32 v128, v40 offset:0
    ds_read_b32 v129, v40 offset:128
    ds_read_b32 v130, v40 offset:256
    ds_read_b32 v131, v40 offset:384
    ds_read_b32 v132, v40 offset:512
    ds_read_b32 v133, v40 offset:640
    ds_read_b32 v134, v40 offset:768
    ds_read_b32 v135, v40 offset:896
    s_waitcnt lgkmcnt(0)
    v_lshlrev_b32 v112, 16, v128
    v_and_b32 v113, 0xffff0000, v128
    v_lshlrev_b32 v114, 16, v129
    v_and_b32 v115, 0xffff0000, v129
    v_lshlrev_b32 v116, 16, v130
    v_and_b32 v117, 0xffff0000, v130
    v_lshlrev_b32 v118, 16, v131
    v_and_b32 v119, 0xffff0000, v131
    v_lshlrev_b32 v120, 16, v132
    v_and_b32 v121, 0xffff0000, v132
    v_lshlrev_b32 v122, 16, v133
    v_and_b32 v123, 0xffff0000, v133
    v_lshlrev_b32 v124, 16, v134
    v_and_b32 v125, 0xffff0000, v134
    v_lshlrev_b32 v126, 16, v135
    v_and_b32 v127, 0xffff0000, v135
    v_lshrrev_b32 v1, 3, v0
    v_lshlrev_b32 v1, 10, v1
    v_and_b32 v2, 7, v0
    v_lshlrev_b32 v2, 4, v2
    v_add_u32 v3, v1, v2
    v_add_u32 v3, 0x200000, v3
    s_lshl_b32 s8, s2, 13
    s_lshl_b32 s6, s3, 7
    s_add_u32 s8, s8, s6
    s_mov_b32 s52, 0
L_poll_116:
    buffer_load_dwordx4 v[176:179], v3, s[28:31], s8 offen sc1
    s_add_u32 s52, s52, 1
    s_cmp_gt_u32 s52, 0x80000
    s_cbranch_scc1 L_end
    s_waitcnt vmcnt(0)
    v_xor_b32 v1, s11, v177
    v_xor_b32 v2, s11, v179
    v_or_b32 v1, v1, v2
    v_cmpx_ne_u32 vcc, 0, v1
    s_cbranch_execnz L_poll_116
L_polld_117:
    s_nop 2
    s_mov_b64 exec, -1
    v_add_f32_dpp v176, v176, v176 row_ror:8 row_mask:0xf bank_mask:0xf
    v_add_f32_dpp v178, v178, v178 row_ror:8 row_mask:0xf bank_mask:0xf
    v_and_b32 v1, 7, v0
    v_lshlrev_b32 v1, 1, v1
    v_permlane16_swap_b32 v176, v178
    v_bfe_u32 v2, v0, 4, 1
    v_add_f32 v176, v176, v178
    v_mov_b32 v178, v176
    v_add_u32 v1, v1, v2
    v_lshlrev_b32 v1, 2, v1
    v_permlane32_swap_b32 v176, v178
    s_lshl_b32 s6, s3, 6
    v_add_f32 v176, v176, v178
    v_cvt_pk_bf16_f32 v176, v176, v176
    v_lshlrev_b32 v176, 16, v176
    v_add_u32 v1, s6, v1
    ds_write_b32 v1, v176 offset:512
    v_lshrrev_b32 v2, 5, v0
    v_lshlrev_b32 v2, 5, v2
    v_add_u32 v2, s6, v2
    ds_read_b128 v[20:23], v2 offset:512
    ds_read_b128 v[24:27], v2 offset:528
    s_waitcnt lgkmcnt(0)
    v_mul_f32 v16, v20, v112
    v_mul_f32 v17, v20, v113
    v_fma_f32 v16, v21, v114, v16
    v_fma_f32 v17, v21, v115, v17
    v_fma_f32 v16, v22, v116, v16
    v_fma_f32 v17, v22, v117, v17
    v_fma_f32 v16, v23, v118, v16
    v_fma_f32 v17, v23, v119, v17
    v_fma_f32 v16, v24, v120, v16
    v_fma_f32 v17, v24, v121, v17
    v_fma_f32 v16, v25, v122, v16
    v_fma_f32 v17, v25, v123, v17
    v_fma_f32 v16, v26, v124, v16
    v_fma_f32 v17, v26, v125, v17
    v_fma_f32 v16, v27, v126, v16
    v_fma_f32 v17, v27, v127, v17
    s_nop 1
    v_permlane32_swap_b32 v16, v17
    s_nop 0
    v_add_f32 v16, v16, v17
    ds_write_b32 v244, v16 offset:512
    s_waitcnt lgkmcnt(0)
    s_barrier
    s_cmp_lg_u32 s3, 0
    s_cbranch_scc1 L_tx
    v_lshlrev_b32 v1, 2, v0
    ds_read_b32 v16, v1 offset:1536
    ds_read_b32 v17, v1 offset:3584
    ds_read_b32 v18, v1 offset:5632
    ds_read_b32 v19, v1 offset:7680
    ds_read_b32 v20, v1 offset:9728
    ds_read_b32 v21, v1 offset:11776
    ds_read_b32 v22, v1 offset:13824
    ds_read_b32 v23, v1 offset:15872
    v_and_b32 v1, 31, v0
    v_lshlrev_b32 v1, 4, v1
    v_lshrrev_b32 v2, 5, v0
    v_lshl_add_u32 v1, v2, 3, v1
    v_add_u32 v1, 0x30000, v1
    s_lshl_b32 s6, s2, 9
    s_waitcnt lgkmcnt(0)
    v_add_f32 v16, v16, v20
    v_add_f32 v17, v17, v21
    v_add_f32 v18, v18, v22
    v_add_f32 v19, v19, v23
    v_add_f32 v16, v16, v18
    v_add_f32 v17, v17, v19
    v_add_f32 v16, v16, v17
    v_mov_b32 v17, s11
    buffer_store_dwordx2 v[16:17], v1, s[28:31], s6 offen sc1
L_tx:
    s_cmp_lg_u32 s59, 6
    s_cbranch_scc1 L_gu
    v_bfe_u32 v3, v0, 3, 2
    v_lshlrev_b32 v3, 12, v3
    v_and_b32 v2, 7, v0
    v_lshl_add_u32 v3, v2, 4, v3
    v_add_u32 v3, 0x30000, v3
    s_lshl_b32 s9, s4, 7
    s_lshl_b32 s8, s3, 14
    s_add_u32 s8, s8, s9
    v_and_b32 v1, 7, v0
    v_lshlrev_b32 v1, 1, v1
    v_bfe_u32 v2, v0, 4, 1
    v_add_u32 v1, v1, v2
    v_lshlrev_b32 v1, 2, v1
    s_lshl_b32 s6, s3, 11
    v_add_u32 v46, s6, v1
    v_bfe_u32 v1, v0, 1, 3
    v_lshlrev_b32 v2, 3, v1
    s_lshl_b32 s6, s4, 6
    v_add_u32 v2, s6, v2
    ds_read_b32 v41, v2 offset:19456
    v_lshlrev_b32 v1, 3, v1
    v_lshrrev_b32 v2, 4, v0
    v_lshl_add_u32 v1, v2, 12, v1
    v_add_u32 v47, 0x20000, v1
    s_add_u32 s63, s9, 16384
    v_lshlrev_b32 v40, 16, v250
    v_and_b32 v42, 15, v0
    v_lshlrev_b32 v42, 2, v42
    v_mov_b32 v45, s11
    s_waitcnt lgkmcnt(0)
    v_lshlrev_b32 v1, 16, v41
    v_and_b32 v2, 0xffff0000, v41
    v_cndmask_b32 v41, v1, v2, s[42:43]
    s_mov_b32 exec_hi, 0
    s_mov_b32 s52, 0
L_poll_118:
    buffer_load_dwordx4 v[176:179], v3, s[28:31], s8 offen sc1
    s_add_u32 s52, s52, 1
    s_cmp_gt_u32 s52, 0x80000
    s_cbranch_scc1 L_end
    s_waitcnt vmcnt(0)
    v_xor_b32 v1, s11, v177
    v_xor_b32 v2, s11, v179
    v_or_b32 v1, v1, v2
    v_cmpx_ne_u32 vcc, 0, v1
    s_cbranch_execnz L_poll_118
L_polld_119:
    s_nop 2
    s_mov_b64 exec, -1
    v_add_f32_dpp v176, v176, v176 row_ror:8 row_mask:0xf bank_mask:0xf
    v_add_f32_dpp v178, v178, v178 row_ror:8 row_mask:0xf bank_mask:0xf
    s_nop 1
    v_permlane16_swap_b32 v176, v178
    s_mov_b32 exec_hi, 0
    v_add_f32 v176, v176, v178
    ds_write_b32 v46, v176 offset:2048
    s_mov_b64 exec, -1
    s_waitcnt lgkmcnt(0)
    s_barrier
    s_cmp_lg_u32 s3, 0
    s_cbranch_scc1 L_fin
    ds_read_b32 v16, v42 offset:2048
    ds_read_b32 v17, v42 offset:4096
    ds_read_b32 v18, v42 offset:6144
    ds_read_b32 v19, v42 offset:8192
    ds_read_b32 v20, v42 offset:10240
    ds_read_b32 v21, v42 offset:12288
    ds_read_b32 v22, v42 offset:14336
    ds_read_b32 v23, v42 offset:16384
    s_waitcnt lgkmcnt(0)
    v_add_f32 v16, v16, v20
    v_add_f32 v17, v17, v21
    v_add_f32 v18, v18, v22
    v_add_f32 v19, v19, v23
    v_add_f32 v16, v16, v18
    v_add_f32 v17, v17, v19
    v_add_f32 v16, v16, v17
    v_cvt_pk_bf16_f32 v16, v16, v16
    v_lshlrev_b32 v16, 16, v16
    v_mul_f32 v16, v41, v16
    v_cvt_pk_bf16_f32 v16, v16, v16
    v_lshlrev_b32 v16, 16, v16
    v_add_f32 v16, v40, v16
    s_nop 1
    v_mov_b32_dpp v17, v16 quad_perm:[1,0,3,2] row_mask:0xf bank_mask:0xf
    s_not_b64 exec, s[42:43]
    v_cvt_pk_bf16_f32 v44, v16, v17
    buffer_store_dwordx2 v[44:45], v47, s[28:31], s9 offen sc1
    buffer_store_dwordx2 v[44:45], v47, s[28:31], s63 offen sc1
    s_mov_b64 exec, -1
    s_branch L_fin
L_gu:
    s_cmp_lg_u32 s61, -1
    s_cbranch_scc1 L_te
    s_cmp_eq_u32 s60, -1
    s_cbranch_scc1 L_fin
    s_lshl_b32 s6, s3, 11
    s_add_u32 s6, s6, 41984
    v_lshlrev_b32 v1, 5, v0
    v_add_u32 v1, s6, v1
    ds_read_b128 v[64:67], v1 offset:0
    ds_read_b128 v[68:71], v1 offset:16
    ds_read_b128 v[72:75], v1 offset:16384
    ds_read_b128 v[76:79], v1 offset:16400
    s_waitcnt lgkmcnt(0)
    v_lshlrev_b32 v128, 16, v64
    v_and_b32 v129, 0xffff0000, v64
    v_lshlrev_b32 v130, 16, v65
    v_and_b32 v131, 0xffff0000, v65
    v_lshlrev_b32 v132, 16, v66
    v_and_b32 v133, 0xffff0000, v66
    v_lshlrev_b32 v134, 16, v67
    v_and_b32 v135, 0xffff0000, v67
    v_lshlrev_b32 v136, 16, v68
    v_and_b32 v137, 0xffff0000, v68
    v_lshlrev_b32 v138, 16, v69
    v_and_b32 v139, 0xffff0000, v69
    v_lshlrev_b32 v140, 16, v70
    v_and_b32 v141, 0xffff0000, v70
    v_lshlrev_b32 v142, 16, v71
    v_and_b32 v143, 0xffff0000, v71
    v_lshlrev_b32 v144, 16, v72
    v_and_b32 v145, 0xffff0000, v72
    v_lshlrev_b32 v146, 16, v73
    v_and_b32 v147, 0xffff0000, v73
    v_lshlrev_b32 v148, 16, v74
    v_and_b32 v149, 0xffff0000, v74
    v_lshlrev_b32 v150, 16, v75
    v_and_b32 v151, 0xffff0000, v75
    v_lshlrev_b32 v152, 16, v76
    v_and_b32 v153, 0xffff0000, v76
    v_lshlrev_b32 v154, 16, v77
    v_and_b32 v155, 0xffff0000, v77
    v_lshlrev_b32 v156, 16, v78
    v_and_b32 v157, 0xffff0000, v78
    v_lshlrev_b32 v158, 16, v79
    v_and_b32 v159, 0xffff0000, v79
    s_lshl_b32 s6, s3, 5
    v_lshrrev_b32 v1, 1, v0
    v_add_u32 v1, s6, v1
    v_lshlrev_b32 v2, 3, v1
    ds_read_b64 v[46:47], v2 offset:17408
    v_bfe_u32 v3, v0, 2, 2
    v_lshlrev_b32 v3, 7, v3
    v_and_b32 v2, 3, v0
    v_lshl_add_u32 v3, v2, 4, v3
    v_add_u32 v3, 0x20000, v3
    s_lshl_b32 s8, s58, 12
    s_lshl_b32 s6, s3, 9
    s_add_u32 s8, s8, s6
    s_lshl_b32 s6, s3, 8
    s_add_u32 s6, s6, 23552
    v_add_u32 v204, s6, v4
    v_add_u32 v205, s6, v240
    v_lshlrev_b32 v206, 5, v0
    s_waitcnt lgkmcnt(0)
    v_lshlrev_b32 v1, 16, v46
    v_and_b32 v2, 0xffff0000, v46
    v_cndmask_b32 v208, v1, v2, s[42:43]
    v_lshlrev_b32 v1, 16, v47
    v_and_b32 v2, 0xffff0000, v47
    v_cndmask_b32 v209, v1, v2, s[42:43]
    s_mov_b64 exec, 0xffff
    s_mov_b32 s52, 0
L_poll_120:
    buffer_load_dwordx4 v[176:179], v3, s[28:31], s8 offen sc1
    s_add_u32 s52, s52, 1
    s_cmp_gt_u32 s52, 0x80000
    s_cbranch_scc1 L_end
    s_waitcnt vmcnt(0)
    v_xor_b32 v1, s11, v177
    v_xor_b32 v2, s11, v179
    v_or_b32 v1, v1, v2
    v_cmpx_ne_u32 vcc, 0, v1
    s_cbranch_execnz L_poll_120
L_polld_121:
    s_nop 2
    s_mov_b64 exec, -1
    v_lshlrev_b32 v180, 16, v176
    v_and_b32 v181, 0xffff0000, v176
    v_lshlrev_b32 v182, 16, v178
    v_and_b32 v183, 0xffff0000, v178
    s_mov_b64 exec, 0xffff
    ds_write_b128 v204, v[180:183]
    s_mov_b64 exec, -1
    s_waitcnt lgkmcnt(0)
    s_barrier
    ds_read_b128 v[188:191], v206 offset:23552
    ds_read_b128 v[192:195], v206 offset:23568
    ds_read_b32 v210, v205
    s_waitcnt lgkmcnt(1)
    v_add_f32 v43, v188, v189
    v_add_f32 v44, v190, v191
    v_add_f32 v45, v192, v193
    v_add_f32 v46, v194, v195
    v_add_f32 v43, v43, v44
    v_add_f32 v45, v45, v46
    v_add_f32 v43, v43, v45
    s_nop 2
    v_add_f32_dpp v43, v43, v43 quad_perm:[1,0,3,2] row_mask:0xf bank_mask:0xf
    s_nop 1
    v_add_f32_dpp v43, v43, v43 quad_perm:[2,3,0,1] row_mask:0xf bank_mask:0xf
    s_nop 1
    v_add_f32_dpp v43, v43, v43 row_ror:4 row_mask:0xf bank_mask:0xf
    s_nop 1
    v_add_f32_dpp v43, v43, v43 row_ror:8 row_mask:0xf bank_mask:0xf
    s_nop 1
    v_mov_b32 v44, v43
    s_nop 1
    v_permlane16_swap_b32 v43, v44
    s_nop 0
    v_add_f32 v43, v43, v44
    v_mov_b32 v44, v43
    s_nop 1
    v_permlane32_swap_b32 v43, v44
    s_nop 0
    v_add_f32 v43, v43, v44
    v_mul_f32 v43, 0x3b000000, v43
    v_sub_f32 v45, v188, v43
    v_sub_f32 v46, v189, v43
    v_mul_f32 v44, v45, v45
    v_mul_f32 v47, v46, v46
    v_sub_f32 v45, v190, v43
    v_sub_f32 v46, v191, v43
    v_fma_f32 v44, v45, v45, v44
    v_fma_f32 v47, v46, v46, v47
    v_sub_f32 v45, v192, v43
    v_sub_f32 v46, v193, v43
    v_fma_f32 v44, v45, v45, v44
    v_fma_f32 v47, v46, v46, v47
    v_sub_f32 v45, v194, v43
    v_sub_f32 v46, v195, v43
    v_fma_f32 v44, v45, v45, v44
    v_fma_f32 v47, v46, v46, v47
    v_add_f32 v44, v44, v47
    s_nop 2
    v_add_f32_dpp v44, v44, v44 quad_perm:[1,0,3,2] row_mask:0xf bank_mask:0xf
    s_nop 1
    v_add_f32_dpp v44, v44, v44 quad_perm:[2,3,0,1] row_mask:0xf bank_mask:0xf
    s_nop 1
    v_add_f32_dpp v44, v44, v44 row_ror:4 row_mask:0xf bank_mask:0xf
    s_nop 1
    v_add_f32_dpp v44, v44, v44 row_ror:8 row_mask:0xf bank_mask:0xf
    s_nop 1
    v_mov_b32 v45, v44
    s_nop 1
    v_permlane16_swap_b32 v44, v45
    s_nop 0
    v_add_f32 v44, v44, v45
    v_mov_b32 v45, v44
    s_nop 1
    v_permlane32_swap_b32 v44, v45
    s_nop 0
    v_add_f32 v44, v44, v45
    v_mul_f32 v44, 0x3b000000, v44
    v_mov_b32 v40, v43
    v_cvt_pk_bf16_f32 v44, v44, v44
    v_cvt_pk_bf16_f32 v40, v40, v40
    v_lshlrev_b32 v44, 16, v44
    v_lshlrev_b32 v40, 16, v40
    v_add_f32 v44, 0x3727c5ac, v44
    v_cvt_pk_bf16_f32 v44, v44, v44
    v_lshlrev_b32 v44, 16, v44
    v_sqrt_f32 v45, v44
    s_nop 0
    v_rcp_f32 v46, v45
    v_fma_f32 v47, -v45, v45, v44
    v_mul_f32 v46, 0.5, v46
    v_fma_f32 v41, v47, v46, v45
    v_cvt_pk_bf16_f32 v41, v41, v41
    v_lshlrev_b32 v41, 16, v41
    v_rcp_f32 v42, v41
    s_nop 0
    v_fma_f32 v45, -v41, v42, 1.0
    v_fma_f32 v42, v45, v42, v42
    s_waitcnt lgkmcnt(0)
    v_sub_f32 v43, v210, v40
    v_add_f32 v209, 1.0, v209
    v_cvt_pk_bf16_f32 v43, v43, v43
    v_cvt_pk_bf16_f32 v209, v209, v209
    v_lshlrev_b32 v43, 16, v43
    v_lshlrev_b32 v209, 16, v209
    v_mul_f32 v44, v43, v42
    v_fma_f32 v3, -v41, v44, v43
    v_fma_f32 v3, v3, v42, v44
    v_cvt_pk_bf16_f32 v3, v3, v3
    v_lshlrev_b32 v3, 16, v3
    v_mul_f32 v3, v3, v209
    v_cvt_pk_bf16_f32 v3, v3, v3
    v_lshlrev_b32 v3, 16, v3
    v_add_f32 v3, v3, v208
    v_cvt_pk_bf16_f32 v3, v3, v3
    v_lshlrev_b32 v3, 16, v3
    v_mul_f32 v16, v3, v128
    v_mul_f32 v17, v3, v129
    v_mul_f32 v18, v3, v130
    v_mul_f32 v19, v3, v131
    v_mul_f32 v20, v3, v132
    v_mul_f32 v21, v3, v133
    v_mul_f32 v22, v3, v134
    v_mul_f32 v23, v3, v135
    v_mul_f32 v24, v3, v136
    v_mul_f32 v25, v3, v137
    v_mul_f32 v26, v3, v138
    v_mul_f32 v27, v3, v139
    v_mul_f32 v28, v3, v140
    v_mul_f32 v29, v3, v141
    v_mul_f32 v30, v3, v142
    v_mul_f32 v31, v3, v143
    v_mul_f32 v212, v3, v144
    v_mul_f32 v213, v3, v145
    v_mul_f32 v214, v3, v146
    v_mul_f32 v215, v3, v147
    v_mul_f32 v216, v3, v148
    v_mul_f32 v217, v3, v149
    v_mul_f32 v218, v3, v150
    v_mul_f32 v219, v3, v151
    v_mul_f32 v220, v3, v152
    v_mul_f32 v221, v3, v153
    v_mul_f32 v222, v3, v154
    v_mul_f32 v223, v3, v155
    v_mul_f32 v224, v3, v156
    v_mul_f32 v225, v3, v157
    v_mul_f32 v226, v3, v158
    v_mul_f32 v227, v3, v159
    v_add_f32_dpp v16, v16, v16 row_ror:8 row_mask:0xf bank_mask:0x3
    v_add_f32_dpp v16, v24, v24 row_ror:8 row_mask:0xf bank_mask:0xc
    v_add_f32_dpp v212, v212, v212 row_ror:8 row_mask:0xf bank_mask:0x3
    v_add_f32_dpp v212, v220, v220 row_ror:8 row_mask:0xf bank_mask:0xc
    v_add_f32_dpp v17, v17, v17 row_ror:8 row_mask:0xf bank_mask:0x3
    v_add_f32_dpp v17, v25, v25 row_ror:8 row_mask:0xf bank_mask:0xc
    v_add_f32_dpp v213, v213, v213 row_ror:8 row_mask:0xf bank_mask:0x3
    v_add_f32_dpp v213, v221, v221 row_ror:8 row_mask:0xf bank_mask:0xc
    v_add_f32_dpp v18, v18, v18 row_ror:8 row_mask:0xf bank_mask:0x3
    v_add_f32_dpp v18, v26, v26 row_ror:8 row_mask:0xf bank_mask:0xc
    v_add_f32_dpp v214, v214, v214 row_ror:8 row_mask:0xf bank_mask:0x3
    v_add_f32_dpp v214, v222, v222 row_ror:8 row_mask:0xf bank_mask:0xc
    v_add_f32_dpp v19, v19, v19 row_ror:8 row_mask:0xf bank_mask:0x3
    v_add_f32_dpp v19, v27, v27 row_ror:8 row_mask:0xf bank_mask:0xc
    v_add_f32_dpp v215, v215, v215 row_ror:8 row_mask:0xf bank_mask:0x3
    v_add_f32_dpp v215, v223, v223 row_ror:8 row_mask:0xf bank_mask:0xc
    v_add_f32_dpp v20, v20, v20 row_ror:8 row_mask:0xf bank_mask:0x3
    v_add_f32_dpp v20, v28, v28 row_ror:8 row_mask:0xf bank_mask:0xc
    v_add_f32_dpp v216, v216, v216 row_ror:8 row_mask:0xf bank_mask:0x3
    v_add_f32_dpp v216, v224, v224 row_ror:8 row_mask:0xf bank_mask:0xc
    v_add_f32_dpp v21, v21, v21 row_ror:8 row_mask:0xf bank_mask:0x3
    v_add_f32_dpp v21, v29, v29 row_ror:8 row_mask:0xf bank_mask:0xc
    v_add_f32_dpp v217, v217, v217 row_ror:8 row_mask:0xf bank_mask:0x3
    v_add_f32_dpp v217, v225, v225 row_ror:8 row_mask:0xf bank_mask:0xc
    v_add_f32_dpp v22, v22, v22 row_ror:8 row_mask:0xf bank_mask:0x3
    v_add_f32_dpp v22, v30, v30 row_ror:8 row_mask:0xf bank_mask:0xc
    v_add_f32_dpp v218, v218, v218 row_ror:8 row_mask:0xf bank_mask:0x3
    v_add_f32_dpp v218, v226, v226 row_ror:8 row_mask:0xf bank_mask:0xc
    v_add_f32_dpp v23, v23, v23 row_ror:8 row_mask:0xf bank_mask:0x3
    v_add_f32_dpp v23, v31, v31 row_ror:8 row_mask:0xf bank_mask:0xc
    v_add_f32_dpp v219, v219, v219 row_ror:8 row_mask:0xf bank_mask:0x3
    v_add_f32_dpp v219, v227, v227 row_ror:8 row_mask:0xf bank_mask:0xc
    v_add_f32_dpp v16, v16, v16 row_shl:4 row_mask:0xf bank_mask:0x5
    v_add_f32_dpp v17, v17, v17 row_shl:4 row_mask:0xf bank_mask:0x5
    v_add_f32_dpp v18, v18, v18 row_shl:4 row_mask:0xf bank_mask:0x5
    v_add_f32_dpp v19, v19, v19 row_shl:4 row_mask:0xf bank_mask:0x5
    v_add_f32_dpp v212, v212, v212 row_shl:4 row_mask:0xf bank_mask:0x5
    v_add_f32_dpp v213, v213, v213 row_shl:4 row_mask:0xf bank_mask:0x5
    v_add_f32_dpp v214, v214, v214 row_shl:4 row_mask:0xf bank_mask:0x5
    v_add_f32_dpp v215, v215, v215 row_shl:4 row_mask:0xf bank_mask:0x5
    v_add_f32_dpp v16, v20, v20 row_shr:4 row_mask:0xf bank_mask:0xa
    v_add_f32_dpp v17, v21, v21 row_shr:4 row_mask:0xf bank_mask:0xa
    v_add_f32_dpp v18, v22, v22 row_shr:4 row_mask:0xf bank_mask:0xa
    v_add_f32_dpp v19, v23, v23 row_shr:4 row_mask:0xf bank_mask:0xa
    v_add_f32_dpp v212, v216, v216 row_shr:4 row_mask:0xf bank_mask:0xa
    v_add_f32_dpp v213, v217, v217 row_shr:4 row_mask:0xf bank_mask:0xa
    v_add_f32_dpp v214, v218, v218 row_shr:4 row_mask:0xf bank_mask:0xa
    v_add_f32_dpp v215, v219, v219 row_shr:4 row_mask:0xf bank_mask:0xa
    v_add_f32_dpp v24, v16, v16 quad_perm:[2,3,0,1] row_mask:0xf bank_mask:0xf
    v_add_f32_dpp v25, v18, v18 quad_perm:[2,3,0,1] row_mask:0xf bank_mask:0xf
    v_add_f32_dpp v26, v17, v17 quad_perm:[2,3,0,1] row_mask:0xf bank_mask:0xf
    v_add_f32_dpp v27, v19, v19 quad_perm:[2,3,0,1] row_mask:0xf bank_mask:0xf
    v_add_f32_dpp v220, v212, v212 quad_perm:[2,3,0,1] row_mask:0xf bank_mask:0xf
    v_add_f32_dpp v221, v214, v214 quad_perm:[2,3,0,1] row_mask:0xf bank_mask:0xf
    v_add_f32_dpp v222, v213, v213 quad_perm:[2,3,0,1] row_mask:0xf bank_mask:0xf
    v_add_f32_dpp v223, v215, v215 quad_perm:[2,3,0,1] row_mask:0xf bank_mask:0xf
    v_cndmask_b32 v16, v24, v25, s[44:45]
    v_cndmask_b32 v17, v26, v27, s[44:45]
    v_cndmask_b32 v212, v220, v221, s[44:45]
    v_cndmask_b32 v213, v222, v223, s[44:45]
    s_nop 0
    v_add_f32_dpp v24, v16, v16 quad_perm:[1,0,3,2] row_mask:0xf bank_mask:0xf
    v_add_f32_dpp v25, v17, v17 quad_perm:[1,0,3,2] row_mask:0xf bank_mask:0xf
    v_add_f32_dpp v220, v212, v212 quad_perm:[1,0,3,2] row_mask:0xf bank_mask:0xf
    v_add_f32_dpp v221, v213, v213 quad_perm:[1,0,3,2] row_mask:0xf bank_mask:0xf
    v_cndmask_b32 v16, v24, v25, s[42:43]
    v_cndmask_b32 v212, v220, v221, s[42:43]
    ds_write_b32 v244, v16 offset:1024
    ds_write_b32 v244, v212 offset:1280
    s_waitcnt lgkmcnt(0)
    s_barrier
    s_cmp_lg_u32 s3, 0
    s_cbranch_scc1 L_fin
    v_add_u32 v1, 2048, v240
    ds_read2st64_b32 v[16:17], v1 offset0:0 offset1:1
    ds_read2st64_b32 v[18:19], v1 offset0:8 offset1:9
    ds_read2st64_b32 v[20:21], v1 offset0:16 offset1:17
    ds_read2st64_b32 v[22:23], v1 offset0:24 offset1:25
    ds_read2st64_b32 v[24:25], v1 offset0:32 offset1:33
    ds_read2st64_b32 v[26:27], v1 offset0:40 offset1:41
    ds_read2st64_b32 v[28:29], v1 offset0:48 offset1:49
    ds_read2st64_b32 v[30:31], v1 offset0:56 offset1:57
    s_lshl_b32 s6, s60, 7
    s_add_u32 s7, s6, 65536
    v_and_b32 v1, 14, v0
    v_lshlrev_b32 v1, 2, v1
    v_lshrrev_b32 v2, 4, v0
    v_lshl_add_u32 v1, v2, 14, v1
    v_add_u32 v47, 0xd0000, v1
    s_mov_b32 s8, 0x3d372713
    s_waitcnt lgkmcnt(0)
    v_add_f32 v16, v16, v24
    v_add_f32 v17, v17, v25
    v_add_f32 v18, v18, v26
    v_add_f32 v19, v19, v27
    v_add_f32 v20, v20, v28
    v_add_f32 v21, v21, v29
    v_add_f32 v22, v22, v30
    v_add_f32 v23, v23, v31
    v_add_f32 v16, v16, v20
    v_add_f32 v17, v17, v21
    v_add_f32 v18, v18, v22
    v_add_f32 v19, v19, v23
    v_add_f32 v16, v16, v18
    v_add_f32 v17, v17, v19
    v_mov_b32 v18, v16
    v_mov_b32 v19, v17
    s_nop 1
    v_permlane16_swap_b32 v16, v18
    v_permlane16_swap_b32 v17, v19
    s_nop 0
    v_add_f32 v16, v16, v18
    v_add_f32 v17, v17, v19
    v_mov_b32 v18, v16
    v_mov_b32 v19, v17
    s_nop 1
    v_permlane32_swap_b32 v16, v18
    v_permlane32_swap_b32 v17, v19
    s_nop 0
    v_add_f32 v16, v16, v18
    v_add_f32 v17, v17, v19
    v_cvt_pk_bf16_f32 v16, v16, v16
    v_cvt_pk_bf16_f32 v17, v17, v17
    v_lshlrev_b32 v16, 16, v16
    v_lshlrev_b32 v17, 16, v17
    v_mul_f32 v18, v16, v16
    v_mul_f32 v18, v18, v16
    v_fma_f32 v18, s8, v18, v16
    v_mul_f32 v18, 0x3f4c422a, v18
    v_mul_f32 v18, 0x4038aa3b, v18
    v_min_f32 v18, 0x42fc0000, v18
    v_exp_f32 v18, v18
    v_mov_b32 v21, 2.0
    v_add_f32 v18, 1.0, v18
    v_rcp_f32 v19, v18
    s_nop 0
    v_fma_f32 v20, -v18, v19, 1.0
    v_fma_f32 v19, v20, v19, v19
    v_mul_f32 v22, v21, v19
    v_fma_f32 v20, -v18, v22, v21
    v_fma_f32 v20, v20, v19, v22
    v_sub_f32 v18, 1.0, v20
    v_add_f32 v18, 1.0, v18
    v_mul_f32 v19, 0.5, v16
    v_mul_f32 v18, v19, v18
    v_cvt_pk_bf16_f32 v18, v18, v18
    v_lshlrev_b32 v18, 16, v18
    v_mul_f32 v18, v18, v17
    v_mov_b32 v21, s11
    s_nop 0
    v_mov_b32_dpp v19, v18 quad_perm:[1,0,3,2] row_mask:0xf bank_mask:0xf
    s_not_b64 exec, s[42:43]
    v_cvt_pk_bf16_f32 v20, v18, v19
    buffer_store_dwordx2 v[20:21], v47, s[28:31], s6 offen sc1
    buffer_store_dwordx2 v[20:21], v47, s[28:31], s7 offen sc1
    s_mov_b64 exec, -1
    s_branch L_fin
L_te:
    s_lshl_b32 s6, s3, 13
    s_add_u32 s6, s6, 41984
    s_cmp_eq_u32 s3, 7
    s_cselect_b32 s6, 41984, s6
    v_lshlrev_b32 v1, 7, v0
    v_add_u32 v1, s6, v1
    ds_read_b128 v[64:67], v1 offset:0
    ds_read_b128 v[68:71], v1 offset:16
    ds_read_b128 v[72:75], v1 offset:32
    ds_read_b128 v[76:79], v1 offset:48
    ds_read_b128 v[80:83], v1 offset:64
    ds_read_b128 v[84:87], v1 offset:80
    ds_read_b128 v[88:91], v1 offset:96
    ds_read_b128 v[92:95], v1 offset:112
    v_bfe_u32 v1, v0, 1, 3
    v_lshlrev_b32 v1, 3, v1
    s_lshl_b32 s6, s61, 6
    v_add_u32 v2, s6, v1
    ds_read_b32 v45, v2 offset:19460
    v_add_u32 v3, 0x20000, v1
    s_lshl_b32 s8, s58, 12
    s_lshl_b32 s6, s61, 7
    s_add_u32 s8, s8, s6
    s_waitcnt lgkmcnt(0)
    v_perm_b32 v128, v72, v64, s48
    v_perm_b32 v129, v72, v64, s49
    v_perm_b32 v130, v73, v65, s48
    v_perm_b32 v131, v73, v65, s49
    v_perm_b32 v132, v74, v66, s48
    v_perm_b32 v133, v74, v66, s49
    v_perm_b32 v134, v75, v67, s48
    v_perm_b32 v135, v75, v67, s49
    v_perm_b32 v136, v76, v68, s48
    v_perm_b32 v137, v76, v68, s49
    v_perm_b32 v138, v77, v69, s48
    v_perm_b32 v139, v77, v69, s49
    v_perm_b32 v140, v78, v70, s48
    v_perm_b32 v141, v78, v70, s49
    v_perm_b32 v142, v79, v71, s48
    v_perm_b32 v143, v79, v71, s49
    v_perm_b32 v144, v88, v80, s48
    v_perm_b32 v145, v88, v80, s49
    v_perm_b32 v146, v89, v81, s48
    v_perm_b32 v147, v89, v81, s49
    v_perm_b32 v148, v90, v82, s48
    v_perm_b32 v149, v90, v82, s49
    v_perm_b32 v150, v91, v83, s48
    v_perm_b32 v151, v91, v83, s49
    v_perm_b32 v152, v92, v84, s48
    v_perm_b32 v153, v92, v84, s49
    v_perm_b32 v154, v93, v85, s48
    v_perm_b32 v155, v93, v85, s49
    v_perm_b32 v156, v94, v86, s48
    v_perm_b32 v157, v94, v86, s49
    v_perm_b32 v158, v95, v87, s48
    v_perm_b32 v159, v95, v87, s49
    v_lshlrev_b32 v1, 16, v45
    v_and_b32 v2, 0xffff0000, v45
    v_cndmask_b32 v45, v1, v2, s[42:43]
    s_mov_b32 s32, s90
    s_mov_b32 s33, s91
    s_mov_b32 s34, 0x400
    s_mov_b32 s35, 0x20000
    s_mov_b32 s52, 0
L_poll_122:
    buffer_load_dwordx2 v[42:43], v3, s[28:31], s8 offen sc1
    s_add_u32 s52, s52, 1
    s_cmp_gt_u32 s52, 0x80000
    s_cbranch_scc1 L_end
    s_waitcnt vmcnt(0)
    v_xor_b32 v1, s11, v43
    v_cmpx_ne_u32 vcc, 0, v1
    s_cbranch_execz L_polld_123
    s_sleep 1
    s_branch L_poll_122
L_polld_123:
    s_nop 2
    s_mov_b64 exec, -1
    v_lshlrev_b32 v1, 16, v42
    v_and_b32 v2, 0xffff0000, v42
    v_cndmask_b32 v44, v1, v2, s[42:43]
    v_mov_b32 v16, 0
    v_mov_b32 v17, 0
    v_mov_b32 v18, 0
    v_mov_b32 v19, 0
    v_mov_b32 v20, 0
    v_mov_b32 v21, 0
    v_mov_b32 v22, 0
    v_mov_b32 v23, 0
    v_mov_b32 v24, 0
    v_mov_b32 v25, 0
    v_mov_b32 v26, 0
    v_mov_b32 v27, 0
    v_mov_b32 v28, 0
    v_mov_b32 v29, 0
    v_mov_b32 v30, 0
    v_mov_b32 v31, 0
    s_cmp_eq_u32 s3, 7
    s_cbranch_scc1 L_nc2
    v_lshrrev_b32 v3, 2, v0
    v_lshlrev_b32 v3, 7, v3
    v_and_b32 v2, 3, v0
    v_lshl_add_u32 v3, v2, 4, v3
    v_add_u32 v3, 0xd0000, v3
    s_lshl_b32 s8, s3, 11
    s_lshl_b32 s6, s58, 14
    s_add_u32 s8, s8, s6
    s_mov_b32 s52, 0
L_poll_124:
    buffer_load_dwordx4 v[176:179], v3, s[28:31], s8 offen sc1
    s_add_u32 s52, s52, 1
    s_cmp_gt_u32 s52, 0x80000
    s_cbranch_scc1 L_end
    s_waitcnt vmcnt(0)
    v_xor_b32 v1, s11, v177
    v_xor_b32 v2, s11, v179
    v_or_b32 v1, v1, v2
    v_cmpx_ne_u32 vcc, 0, v1
    s_cbranch_execnz L_poll_124
L_polld_125:
    s_nop 2
    s_mov_b64 exec, -1
    v_dot2_f32_bf16 v16, v128, v176, v16
    v_dot2_f32_bf16 v17, v129, v176, v17
    v_dot2_f32_bf16 v18, v130, v176, v18
    v_dot2_f32_bf16 v19, v131, v176, v19
    v_dot2_f32_bf16 v20, v132, v176, v20
    v_dot2_f32_bf16 v21, v133, v176, v21
    v_dot2_f32_bf16 v22, v134, v176, v22
    v_dot2_f32_bf16 v23, v135, v176, v23
    v_dot2_f32_bf16 v24, v136, v176, v24
    v_dot2_f32_bf16 v25, v137, v176, v25
    v_dot2_f32_bf16 v26, v138, v176, v26
    v_dot2_f32_bf16 v27, v139, v176, v27
    v_dot2_f32_bf16 v28, v140, v176, v28
    v_dot2_f32_bf16 v29, v141, v176, v29
    v_dot2_f32_bf16 v30, v142, v176, v30
    v_dot2_f32_bf16 v31, v143, v176, v31
    v_dot2_f32_bf16 v16, v144, v178, v16
    v_dot2_f32_bf16 v17, v145, v178, v17
    v_dot2_f32_bf16 v18, v146, v178, v18
    v_dot2_f32_bf16 v19, v147, v178, v19
    v_dot2_f32_bf16 v20, v148, v178, v20
    v_dot2_f32_bf16 v21, v149, v178, v21
    v_dot2_f32_bf16 v22, v150, v178, v22
    v_dot2_f32_bf16 v23, v151, v178, v23
    v_dot2_f32_bf16 v24, v152, v178, v24
    v_dot2_f32_bf16 v25, v153, v178, v25
    v_dot2_f32_bf16 v26, v154, v178, v26
    v_dot2_f32_bf16 v27, v155, v178, v27
    v_dot2_f32_bf16 v28, v156, v178, v28
    v_dot2_f32_bf16 v29, v157, v178, v29
    v_dot2_f32_bf16 v30, v158, v178, v30
    v_dot2_f32_bf16 v31, v159, v178, v31
L_nc2:
    s_nop 2
    v_add_f32_dpp v16, v16, v16 row_ror:8 row_mask:0xf bank_mask:0x3
    v_add_f32_dpp v16, v24, v24 row_ror:8 row_mask:0xf bank_mask:0xc
    v_add_f32_dpp v17, v17, v17 row_ror:8 row_mask:0xf bank_mask:0x3
    v_add_f32_dpp v17, v25, v25 row_ror:8 row_mask:0xf bank_mask:0xc
    v_add_f32_dpp v18, v18, v18 row_ror:8 row_mask:0xf bank_mask:0x3
    v_add_f32_dpp v18, v26, v26 row_ror:8 row_mask:0xf bank_mask:0xc
    v_add_f32_dpp v19, v19, v19 row_ror:8 row_mask:0xf bank_mask:0x3
    v_add_f32_dpp v19, v27, v27 row_ror:8 row_mask:0xf bank_mask:0xc
    v_add_f32_dpp v20, v20, v20 row_ror:8 row_mask:0xf bank_mask:0x3
    v_add_f32_dpp v20, v28, v28 row_ror:8 row_mask:0xf bank_mask:0xc
    v_add_f32_dpp v21, v21, v21 row_ror:8 row_mask:0xf bank_mask:0x3
    v_add_f32_dpp v21, v29, v29 row_ror:8 row_mask:0xf bank_mask:0xc
    v_add_f32_dpp v22, v22, v22 row_ror:8 row_mask:0xf bank_mask:0x3
    v_add_f32_dpp v22, v30, v30 row_ror:8 row_mask:0xf bank_mask:0xc
    v_add_f32_dpp v23, v23, v23 row_ror:8 row_mask:0xf bank_mask:0x3
    v_add_f32_dpp v23, v31, v31 row_ror:8 row_mask:0xf bank_mask:0xc
    v_add_f32_dpp v16, v16, v16 row_shl:4 row_mask:0xf bank_mask:0x5
    v_add_f32_dpp v17, v17, v17 row_shl:4 row_mask:0xf bank_mask:0x5
    v_add_f32_dpp v18, v18, v18 row_shl:4 row_mask:0xf bank_mask:0x5
    v_add_f32_dpp v19, v19, v19 row_shl:4 row_mask:0xf bank_mask:0x5
    v_add_f32_dpp v16, v20, v20 row_shr:4 row_mask:0xf bank_mask:0xa
    v_add_f32_dpp v17, v21, v21 row_shr:4 row_mask:0xf bank_mask:0xa
    v_add_f32_dpp v18, v22, v22 row_shr:4 row_mask:0xf bank_mask:0xa
    v_add_f32_dpp v19, v23, v23 row_shr:4 row_mask:0xf bank_mask:0xa
    v_add_f32_dpp v24, v16, v16 quad_perm:[2,3,0,1] row_mask:0xf bank_mask:0xf
    v_add_f32_dpp v25, v18, v18 quad_perm:[2,3,0,1] row_mask:0xf bank_mask:0xf
    v_add_f32_dpp v26, v17, v17 quad_perm:[2,3,0,1] row_mask:0xf bank_mask:0xf
    v_add_f32_dpp v27, v19, v19 quad_perm:[2,3,0,1] row_mask:0xf bank_mask:0xf
    v_cndmask_b32 v16, v24, v25, s[44:45]
    v_cndmask_b32 v17, v26, v27, s[44:45]
    s_nop 1
    v_add_f32_dpp v24, v16, v16 quad_perm:[1,0,3,2] row_mask:0xf bank_mask:0xf
    v_add_f32_dpp v25, v17, v17 quad_perm:[1,0,3,2] row_mask:0xf bank_mask:0xf
    v_cndmask_b32 v16, v24, v25, s[42:43]
    ds_write_b32 v244, v16 offset:1536
    v_lshlrev_b32 v1, 2, v0
    v_lshlrev_b32 v3, 1, v0
    s_lshl_b32 s6, s61, 5
    s_waitcnt lgkmcnt(0)
    s_barrier
    s_cmp_lg_u32 s3, 0
    s_cbranch_scc1 L_fin
    ds_read_b32 v16, v1 offset:2560
    ds_read_b32 v17, v1 offset:4608
    ds_read_b32 v18, v1 offset:6656
    ds_read_b32 v19, v1 offset:8704
    ds_read_b32 v20, v1 offset:10752
    ds_read_b32 v21, v1 offset:12800
    ds_read_b32 v22, v1 offset:14848
    ds_read_b32 v23, v1 offset:16896
    s_waitcnt lgkmcnt(0)
    v_add_f32 v16, v16, v20
    v_add_f32 v17, v17, v21
    v_add_f32 v18, v18, v22
    v_add_f32 v19, v19, v23
    v_add_f32 v16, v16, v18
    v_add_f32 v17, v17, v19
    v_add_f32 v16, v16, v17
    v_mov_b32 v17, v16
    s_nop 1
    v_permlane16_swap_b32 v16, v17
    s_nop 0
    v_add_f32 v16, v16, v17
    v_mov_b32 v17, v16
    s_nop 1
    v_permlane32_swap_b32 v16, v17
    s_nop 0
    v_add_f32 v16, v16, v17
    v_cvt_pk_bf16_f32 v16, v16, v16
    v_lshlrev_b32 v16, 16, v16
    v_mul_f32 v16, v45, v16
    v_cvt_pk_bf16_f32 v16, v16, v16
    v_lshlrev_b32 v16, 16, v16
    v_add_f32 v16, v44, v16
    s_nop 1
    v_mov_b32_dpp v17, v16 quad_perm:[1,0,3,2] row_mask:0xf bank_mask:0xf
    s_mov_b64 exec, 0x5555
    v_cvt_pk_bf16_f32 v18, v16, v17
    buffer_store_dword v18, v3, s[32:35], s6 offen
    s_mov_b64 exec, -1
L_fin:
L_end:
    s_endpgm
.section .rodata,"a"
.p2align 6
.amdhsa_kernel adaLN_cond__mha_block_cached__glu_gated_geglu__decode_kernel
  .amdhsa_next_free_vgpr 256
  .amdhsa_next_free_sgpr 102
  .amdhsa_accum_offset 256
  .amdhsa_group_segment_fixed_size 0
  .amdhsa_kernarg_size 112
  .amdhsa_user_sgpr_count 2
  .amdhsa_user_sgpr_kernarg_segment_ptr 1
  .amdhsa_system_sgpr_workgroup_id_x 1
  .amdhsa_float_denorm_mode_32 3
.end_amdhsa_kernel
```
